```python
import torch

def _softmax(x, axis=-1):
    return torch.softmax(x, dim=axis)
def _gelu(x):
    return torch.nn.functional.gelu(x, approximate="tanh")
def _silu(x):
    return torch.nn.functional.silu(x)
def _sigmoid(x):
    return torch.sigmoid(x)
def _layernorm(x, axis=-1, eps=1e-5):
    m = x.mean(dim=axis, keepdim=True)
    v = x.var(dim=axis, keepdim=True, unbiased=False)
    return (x - m) / torch.sqrt(v + eps)
def _scatter_add(tgt, idx, src, axis=0):
    return tgt.clone().index_add_(axis, idx, src)
def _segment_sum(src, seg, n):
    out = torch.zeros((n,) + src.shape[1:], dtype=src.dtype)
    return out.index_add_(0, seg, src)
def _pad(x, pw):
    flat = tuple(v for pair in reversed(pw) for v in pair)
    return torch.nn.functional.pad(x, flat)

kernel_name = 'interleave_layers__mha_block_cached__swiglu_ffn__decode'

def setup_inputs():

    _w = (lambda a: (lambda t: t.to(torch.bfloat16) if t.is_floating_point() else t)(torch.as_tensor(a)))
    def _A_setup():
        B, Sq, D = 1, 1, 512
        H, Sk, Dh = 32, 4096, 128
        return {
            "x": _w((lambda *s: torch.randn(*s, dtype=torch.bfloat16) * 0.05)(B, Sq, D)),
            "k_cache": _w((lambda *s: torch.randn(*s, dtype=torch.bfloat16) * 1.6)(B, H, Sk, Dh)),
            "v_cache": _w((lambda *s: torch.randn(*s, dtype=torch.bfloat16) * 1.6)(B, H, Sk, Dh)),
            "wq": _w((lambda *s: torch.randn(*s, dtype=torch.bfloat16) * 1.6)(D, H * Dh) * (D ** -0.5)),
            "wo": _w((lambda *s: torch.randn(*s, dtype=torch.bfloat16) * 1.6)(H * Dh, D) * ((H * Dh) ** -0.5)),
        }
    _A_in = _A_setup()

    def _B_setup():
        B, S, D, F = 1, 1, 512, 1376
        return {
            "x": _w((lambda *s: torch.randn(*s, dtype=torch.bfloat16) * 0.05)(B, S, D)),
            "w_gate": _w((lambda *s: torch.randn(*s, dtype=torch.bfloat16) * 0.05)(D, F)),
            "w_up": _w((lambda *s: torch.randn(*s, dtype=torch.bfloat16) * 0.05)(D, F)),
            "w_down": _w((lambda *s: torch.randn(*s, dtype=torch.bfloat16) * 0.05)(F, D)),
        }
    _B_in = _B_setup()

    return {
        "A_x": _A_in["x"],
        "A_k_cache": _A_in["k_cache"],
        "A_v_cache": _A_in["v_cache"],
        "A_wq": _A_in["wq"],
        "A_wo": _A_in["wo"],
        "B_x": _B_in["x"],
        "B_w_gate": _B_in["w_gate"],
        "B_w_up": _B_in["w_up"],
        "B_w_down": _B_in["w_down"],
    }

def reference(A_x, A_k_cache, A_v_cache, A_wq, A_wo, B_x, B_w_gate, B_w_up, B_w_down):
    def _A_ref(x, k_cache, v_cache, wq, wo):
        B, Sq, D = x.shape
        H, Dh = 32, 128
        q = (lambda x, *d: x.permute(*d))((x @ wq).reshape(B, Sq, H, Dh), 0, 2, 1, 3)
        scores = torch.einsum("bhqd,bhkd->bhqk", q, k_cache) * (Dh ** -0.5)
        p = _softmax(scores, axis=-1)
        o = torch.einsum("bhqk,bhkd->bhqd", p, v_cache)
        return (lambda x, *d: x.permute(*d))(o, 0, 2, 1, 3).reshape(B, Sq, H * Dh) @ wo

    def _B_ref(x, w_gate, w_up, w_down):
        g = _silu(x @ w_gate)
        u = x @ w_up
        return (g * u) @ w_down

    x = A_x
    x = x + _A_ref(_layernorm(x, axis=-1), A_k_cache, A_v_cache, A_wq, A_wo)
    x = x + _B_ref(_layernorm(x, axis=-1), B_w_gate, B_w_up, B_w_down)
    x = x + _A_ref(_layernorm(x, axis=-1), A_k_cache, A_v_cache, A_wq, A_wo)
    x = x + _B_ref(_layernorm(x, axis=-1), B_w_gate, B_w_up, B_w_down)
    return x
```

```asm
; @launch grid=(256,1,1) block=(256,1,1) lds=163840
.amdgcn_target "amdgcn-amd-amdhsa--gfx950"
.text
.globl interleave_layers__mha_block_cached__swiglu_ffn__decode_kernel
.p2align 8
.type interleave_layers__mha_block_cached__swiglu_ffn__decode_kernel,@function
interleave_layers__mha_block_cached__swiglu_ffn__decode_kernel:
    s_cmp_ge_u32 s2, 256
    s_cbranch_scc1 L_end
    s_load_dwordx2 s[40:41], s[0:1], 88
    s_load_dwordx2 s[16:17], s[0:1], 24
    s_load_dwordx2 s[8:9], s[0:1], 8
    s_load_dwordx2 s[4:5], s[0:1], 0
    v_lshrrev_b32 v112, 6, v0
    s_and_b32 s56, s2, 7
    s_lshr_b32 s57, s2, 6
    v_readfirstlane_b32 s54, v112
    s_lshl2_add_u32 s52, s56, s57
    s_bfe_u32 s53, s2, 0x30003
    s_lshl_b32 s62, s52, 14
    s_lshl_b32 s66, s53, 12
    s_add_u32 s66, s66, 524288
    s_lshl_b32 s56, s52, 7
    v_lshrrev_b32 v215, 3, v0
    v_lshl_add_u32 v216, v215, 15, s56
    v_and_b32 v217, 7, v0
    v_lshl_add_u32 v216, v217, 4, v216
    v_mov_b32 v212, 2147483648
    v_cmp_gt_u32 vcc, 200, v0
    v_mov_b64 v[208:209], -1
    v_mov_b64 v[210:211], -1
    v_cndmask_b32 v216, v212, v216, vcc
    v_and_b32 v1, 63, v0
    s_lshl_b32 s56, s53, 8
    v_lshrrev_b32 v215, 5, v0
    v_lshl_add_u32 v217, v215, 11, s56
    v_and_b32 v215, 31, v0
    v_lshl_add_u32 v217, v215, 3, v217
    s_lshl_b32 s56, s53, 19
    s_lshl_b32 s57, s52, 8
    s_add_u32 s56, s56, s57
    v_and_b32 v2, 15, v0
    v_and_b32 v5, 16, v0
    v_and_b32 v112, 0xe0, v0
    v_lshl_add_u32 v192, v5, 12, s56
    v_lshl_add_u32 v192, v112, 8, v192
    v_lshl_add_u32 v192, v2, 4, v192
    s_lshl_b32 s56, s52, 20
    s_lshl_b32 s57, s53, 17
    s_add_u32 s56, s56, s57
    v_lshl_add_u32 v4, v0, 4, s56
    v_lshlrev_b32 v5, 3, v5
    v_xor_b32 v5, v5, v4
    v_bfe_u32 v3, v0, 4, 2
    s_lshl_b32 s56, s53, 7
    v_lshl_add_u32 v222, v3, 5, s56
    v_lshlrev_b32 v52, 4, v1
    s_mul_i32 s55, s54, 33280
    s_lshl_b32 s57, s54, 12
    s_mov_b32 s42, 268435456
    s_mov_b32 s43, 0x20000
    s_mov_b32 s18, 0x400000
    s_mov_b32 s19, 0x20000
    s_mov_b32 s10, 0x2000000
    s_mov_b32 s11, 0x20000
    s_mov_b32 s6, 1024
    s_mov_b32 s7, 0x20000
    s_waitcnt lgkmcnt(0)
    buffer_store_dwordx2 v[208:209], v217, s[40:43], s62 offen offset:0 sc1
    buffer_store_dwordx4 v[208:211], v216, s[40:43], s66 offen offset:0 sc1
    s_add_u32 m0, s57, 133120
    s_mov_b32 s58, 0
    buffer_load_dwordx4 v192, s[16:19], s58 offen nt lds
    s_add_u32 m0, s57, 134144
    s_mov_b32 s58, 131072
    buffer_load_dwordx4 v192, s[16:19], s58 offen nt lds
    s_add_u32 m0, s57, 135168
    s_mov_b32 s58, 262144
    buffer_load_dwordx4 v192, s[16:19], s58 offen nt lds
    s_add_u32 m0, s57, 136192
    s_mov_b32 s58, 393216
    buffer_load_dwordx4 v192, s[16:19], s58 offen nt lds
    buffer_load_dwordx4 v[196:199], v222, s[4:7], 0 offen
    buffer_load_dwordx4 v[200:203], v222, s[4:7], 0 offen offset:16
    buffer_load_dwordx4 v[204:207], v52, s[4:7], 0 offen
    s_add_u32 m0, s55, 0
    s_mov_b32 s58, 0
    buffer_load_dwordx4 v5, s[8:11], s58 offen nt lds
    s_add_u32 m0, s55, 1040
    s_mov_b32 s58, 16384
    buffer_load_dwordx4 v5, s[8:11], s58 offen nt lds
    s_add_u32 m0, s55, 2080
    s_mov_b32 s58, 32768
    buffer_load_dwordx4 v5, s[8:11], s58 offen nt lds
    s_add_u32 m0, s55, 3120
    s_mov_b32 s58, 49152
    buffer_load_dwordx4 v5, s[8:11], s58 offen nt lds
    s_add_u32 m0, s55, 4160
    s_mov_b32 s58, 65536
    buffer_load_dwordx4 v5, s[8:11], s58 offen nt lds
    s_add_u32 m0, s55, 5200
    s_mov_b32 s58, 81920
    buffer_load_dwordx4 v5, s[8:11], s58 offen nt lds
    s_add_u32 m0, s55, 6240
    s_mov_b32 s58, 98304
    buffer_load_dwordx4 v5, s[8:11], s58 offen nt lds
    s_add_u32 m0, s55, 7280
    s_mov_b32 s58, 114688
    buffer_load_dwordx4 v5, s[8:11], s58 offen nt lds
    s_load_dwordx2 s[12:13], s[0:1], 16
    s_load_dwordx2 s[20:21], s[0:1], 32
    s_load_dwordx2 s[24:25], s[0:1], 48
    s_load_dwordx2 s[70:71], s[0:1], 56
    s_load_dwordx2 s[28:29], s[0:1], 64
    s_load_dwordx2 s[32:33], s[0:1], 72
    s_load_dwordx2 s[36:37], s[0:1], 80
    s_mov_b32 s14, 0x2000000
    s_mov_b32 s15, 0x20000
    s_mov_b32 s22, 0x400000
    s_mov_b32 s23, 0x20000
    s_mov_b32 s26, 1409024
    s_mov_b32 s27, 0x20000
    s_mov_b32 s30, 1409024
    s_mov_b32 s31, 0x20000
    s_mov_b32 s34, 1024
    s_mov_b32 s35, 0x20000
    s_mov_b32 s38, 256
    s_mov_b32 s39, 0x20000
    s_mov_b32 s44, 0xcccccccc
    s_mov_b32 s45, 0xcccccccc
    s_mov_b32 s50, 0xaaaaaaaa
    s_mov_b32 s51, 0xaaaaaaaa
    s_mov_b32 s59, 0
    s_mov_b32 s60, -2
    s_add_u32 s63, s62, 4096
    s_add_u32 s64, s62, 8192
    s_add_u32 s65, s62, 12288
    s_add_u32 s67, s66, 262144
    s_add_u32 s68, s66, 524288
    s_add_u32 s69, s66, 786432
    s_add_u32 s47, s66, 131072
    s_add_u32 s48, s66, 393216
    s_add_u32 s49, s66, 655360
    v_bfe_u32 v213, v0, 2, 2
    v_and_b32 v214, 3, v0
    s_getreg_b32 s61, hwreg(HW_REG_XCC_ID, 0, 4)
    s_or_b32 s61, s61, 0x80
    s_lshl3_add_u32 s56, s52, s53
    v_mov_b32 v215, s56
    v_mov_b32 v220, s61
    v_cmp_eq_u32 vcc, 0, v0
    s_nop 1
    v_cndmask_b32 v219, v212, v215, vcc
    s_lshl_b32 s56, s53, 8
    s_lshl_b32 s57, s54, 5
    s_add_u32 s57, s57, s56
    v_lshl_add_u32 v216, v3, 3, s57
    v_bfe_u32 v218, v0, 1, 1
    v_lshl_add_u32 v216, v218, 7, v216
    v_add_u32 v217, 6144, v216
    v_and_b32 v215, 13, v0
    v_cmp_eq_u32 vcc, 0, v215
    s_nop 1
    v_cndmask_b32 v8, v212, v216, vcc
    v_cmp_eq_u32 vcc, 1, v215
    s_nop 1
    v_cndmask_b32 v221, v8, v217, vcc
    v_and_b32 v215, 1, v0
    v_lshl_add_u32 v216, v215, 7, s56
    v_lshrrev_b32 v217, 1, v1
    v_lshl_add_u32 v48, v217, 2, v216
    v_lshl_add_u32 v216, v213, 1, v215
    v_lshlrev_b32 v216, 8, v216
    v_lshl_add_u32 v216, v3, 4, v216
    v_lshl_add_u32 v9, v218, 7, v216
    v_mul_u32_u24 v217, 0xaaaa, v218
    v_add_u32 v12, 0x4444, v217
    v_lshlrev_b32 v10, 4, v214
    s_lshl_b32 s56, s53, 3
    v_mov_b32 v216, s56
    v_cmp_eq_u32 vcc, 0, v1
    s_nop 1
    v_cndmask_b32 v11, v212, v216, vcc
    s_lshl2_add_u32 s56, s53, s54
    s_lshl_b32 s56, s56, 3
    v_mov_b32 v216, s56
    v_cmp_eq_u32 vcc, 63, v1
    s_nop 1
    v_cndmask_b32 v49, v212, v216, vcc
    v_lshl_add_u32 v216, v3, 2, v2
    v_and_b32 v216, 15, v216
    v_lshlrev_b32 v50, 4, v216
    v_mov_b32 v216, 0x0000ffff
    v_mov_b32 v217, 0xffff0000
    v_cmp_eq_u32 vcc, 3, v214
    s_nop 1
    v_cndmask_b32 v14, v216, v217, vcc
    v_cndmask_b32 v216, v214, 0, vcc
    v_or_b32 v216, 12, v216
    v_mul_u32_u24 v13, 0x1111, v216
    s_mul_i32 s56, s52, 48
    s_sub_i32 s56, 1376, s56
    s_min_i32 s56, s56, 48
    v_cmp_gt_i32 vcc, s56, v1
    s_nop 1
    v_cndmask_b32 v216, 0, v14, vcc
    v_cmp_eq_u32 vcc, 0, v213
    s_nop 1
    v_cndmask_b32 v57, 0, v216, vcc
    v_cmp_eq_u32 vcc, 1, v213
    s_nop 1
    v_cndmask_b32 v58, 0, v216, vcc
    v_cmp_eq_u32 vcc, 2, v213
    s_nop 1
    v_cndmask_b32 v59, 0, v216, vcc
    v_cmp_eq_u32 vcc, 3, v213
    s_nop 1
    v_cndmask_b32 v60, 0, v216, vcc
    v_lshlrev_b32 v217, 4, v214
    v_mov_b32 v218, 0x3f80
    v_lshlrev_b32 v217, v217, v218
    v_cmp_gt_u32 vcc, 2, v214
    s_nop 1
    v_cndmask_b32 v217, 0, v217, vcc
    v_cmp_eq_u32 vcc, v213, v3
    s_nop 1
    v_cndmask_b32 v217, 0, v217, vcc
    v_mov_b32 v208, 0x3f803f80
    v_cndmask_b32 v216, v208, 0, s[50:51]
    v_cndmask_b32 v218, 0, v208, s[50:51]
    v_accvgpr_write_b32 a208, v216
    v_accvgpr_write_b32 a212, v217
    v_accvgpr_write_b32 a216, v216
    v_accvgpr_write_b32 a209, v216
    v_accvgpr_write_b32 a213, v217
    v_accvgpr_write_b32 a217, v216
    v_accvgpr_write_b32 a210, v216
    v_accvgpr_write_b32 a214, v217
    v_accvgpr_write_b32 a218, v218
    v_accvgpr_write_b32 a211, v216
    v_accvgpr_write_b32 a215, v217
    v_accvgpr_write_b32 a219, v218
    s_lshl_b32 s56, s54, 9
    s_add_u32 s57, s56, 153856
    v_lshl_add_u32 v44, v2, 5, s57
    v_mov_b32 v46, 156912
    s_lshl_b32 s57, s54, 2
    s_add_u32 s57, s57, 155904
    v_add_u32 v45, s57, v52
    v_lshlrev_b32 v216, 3, v1
    v_add_u32 v47, 153856, v216
    v_add_u32 v53, 149504, v216
    s_add_u32 s57, s56, 149504
    v_lshrrev_b32 v216, 3, v1
    v_lshl_add_u32 v216, v216, 5, s57
    v_bfe_u32 v217, v0, 1, 2
    v_lshl_add_u32 v216, v217, 3, v216
    v_mul_u32_u24 v217, 2176, v215
    v_add_u32 v54, v216, v217
    v_mov_b32 v15, 0x3727c5ac
    s_lshl1_add_u32 s56, s52, s54
    s_lshl_b32 s56, s56, 6
    v_lshl_add_u32 v216, v3, 15, s56
    v_lshl_add_u32 v51, v2, 2, v216
    s_and_b32 s56, s2, 7
    s_lshl4_add_u32 s56, s56, s54
    s_lshl_b32 s56, s56, 11
    v_add_u32 v52, s56, v52
    s_lshl_b32 s56, s54, 9
    s_lshl2_add_u32 s56, s53, s56
    v_lshl_add_u32 v216, v2, 5, s56
    v_cmp_eq_u32 vcc, 0, v3
    s_nop 1
    v_cndmask_b32 v55, v212, v216, vcc
    v_min_u32 v216, 47, v1
    v_lshlrev_b32 v56, 5, v216
    s_lshl_b32 s56, s53, 7
    v_lshrrev_b32 v216, 3, v1
    v_lshl_add_u32 v216, v216, 10, s56
    v_and_b32 v217, 7, v0
    v_lshl_add_u32 v216, v217, 4, v216
    s_lshl_b32 s56, s52, 17
    s_lshl_b32 s57, s54, 15
    s_add_u32 s56, s56, s57
    v_add_u32 v6, s56, v216
    s_and_b32 s57, s54, 1
    s_lshl1_add_u32 s56, s52, s57
    s_mul_i32 s56, s56, 24576
    v_add_u32 v7, s56, v216
    s_mul_i32 s56, s53, 176128
    s_mul_i32 s57, s52, 96
    s_add_u32 s56, s56, s57
    v_add_u32 v216, 0, v1
    v_mul_u32_u24 v217, 10923, v216
    v_lshrrev_b32 v217, 16, v217
    v_mul_u32_u24 v218, 6, v217
    v_sub_u32 v216, v216, v218
    v_lshl_add_u32 v61, v216, 4, s56
    v_bfe_u32 v216, v217, 1, 1
    v_lshrrev_b32 v218, 4, v217
    v_lshl_add_u32 v216, v218, 1, v216
    v_and_b32 v218, 1, v217
    v_lshl_add_u32 v216, v218, 3, v216
    v_and_b32 v218, 12, v217
    v_lshl_add_u32 v216, v218, 2, v216
    v_mul_u32_u24 v216, 2752, v216
    v_add_u32 v61, v61, v216
    v_add_u32 v216, 64, v1
    v_mul_u32_u24 v217, 10923, v216
    v_lshrrev_b32 v217, 16, v217
    v_mul_u32_u24 v218, 6, v217
    v_sub_u32 v216, v216, v218
    v_lshl_add_u32 v62, v216, 4, s56
    v_bfe_u32 v216, v217, 1, 1
    v_lshrrev_b32 v218, 4, v217
    v_lshl_add_u32 v216, v218, 1, v216
    v_and_b32 v218, 1, v217
    v_lshl_add_u32 v216, v218, 3, v216
    v_and_b32 v218, 12, v217
    v_lshl_add_u32 v216, v218, 2, v216
    v_mul_u32_u24 v216, 2752, v216
    v_add_u32 v62, v62, v216
    v_add_u32 v216, 128, v1
    v_mul_u32_u24 v217, 10923, v216
    v_lshrrev_b32 v217, 16, v217
    v_mul_u32_u24 v218, 6, v217
    v_sub_u32 v216, v216, v218
    v_lshl_add_u32 v63, v216, 4, s56
    v_bfe_u32 v216, v217, 1, 1
    v_lshrrev_b32 v218, 4, v217
    v_lshl_add_u32 v216, v218, 1, v216
    v_and_b32 v218, 1, v217
    v_lshl_add_u32 v216, v218, 3, v216
    v_and_b32 v218, 12, v217
    v_lshl_add_u32 v216, v218, 2, v216
    v_mul_u32_u24 v216, 2752, v216
    v_add_u32 v63, v63, v216
    s_lshl_b32 s56, s54, 6
    s_add_u32 s56, s56, 133120
    v_lshrrev_b32 v216, 2, v1
    v_lshl_add_u32 v216, v216, 8, s56
    v_lshl_add_u32 v64, v214, 4, v216
    s_waitcnt lgkmcnt(0)
    s_cmp_eq_u32 s54, 3
    s_cselect_b32 s24, s70, s24
    s_cselect_b32 s25, s71, s25
    s_waitcnt vmcnt(15)
    s_barrier
    buffer_store_byte v220, v219, s[36:39], 0 offen
    s_waitcnt vmcnt(11)
    s_add_u32 m0, s55, 8320
    s_mov_b32 s58, 4096
    buffer_load_dwordx4 v5, s[8:11], s58 offen nt lds
    s_waitcnt vmcnt(11)
    s_add_u32 m0, s55, 9360
    s_mov_b32 s58, 20480
    buffer_load_dwordx4 v5, s[8:11], s58 offen nt lds
    s_waitcnt vmcnt(11)
    s_add_u32 m0, s55, 10400
    s_mov_b32 s58, 36864
    buffer_load_dwordx4 v5, s[8:11], s58 offen nt lds
    s_barrier
    ds_read_b64_tr_b16 a[128:129], v64 offset:0
    ds_read_b64_tr_b16 a[130:131], v64 offset:4096
    ds_read_b64_tr_b16 a[132:133], v64 offset:8192
    ds_read_b64_tr_b16 a[134:135], v64 offset:12288
    ds_read_b64_tr_b16 a[136:137], v64 offset:8
    ds_read_b64_tr_b16 a[138:139], v64 offset:4104
    ds_read_b64_tr_b16 a[140:141], v64 offset:8200
    ds_read_b64_tr_b16 a[142:143], v64 offset:12296
    v_cndmask_b32 v196, v196, v208, s[50:51]
    v_cndmask_b32 v197, v197, v208, s[50:51]
    v_cndmask_b32 v198, v198, v208, s[50:51]
    v_cndmask_b32 v199, v199, v208, s[50:51]
    v_cndmask_b32 v200, v200, v208, s[50:51]
    v_cndmask_b32 v201, v201, v208, s[50:51]
    v_cndmask_b32 v202, v202, v208, s[50:51]
    v_cndmask_b32 v203, v203, v208, s[50:51]
    v_lshlrev_b32 v16, 16, v196
    v_and_b32 v18, 0xffff0000, v196
    v_lshlrev_b32 v17, 16, v200
    v_and_b32 v19, 0xffff0000, v200
    v_lshlrev_b32 v20, 16, v197
    v_and_b32 v22, 0xffff0000, v197
    v_lshlrev_b32 v21, 16, v201
    v_and_b32 v23, 0xffff0000, v201
    v_lshlrev_b32 v24, 16, v198
    v_and_b32 v26, 0xffff0000, v198
    v_lshlrev_b32 v25, 16, v202
    v_and_b32 v27, 0xffff0000, v202
    v_lshlrev_b32 v28, 16, v199
    v_and_b32 v30, 0xffff0000, v199
    v_lshlrev_b32 v29, 16, v203
    v_and_b32 v31, 0xffff0000, v203
    v_cvt_pk_bf16_f32 v32, v16, v17
    v_cvt_pk_bf16_f32 v33, v18, v19
    v_cvt_pk_bf16_f32 v34, v20, v21
    v_cvt_pk_bf16_f32 v35, v22, v23
    v_cvt_pk_bf16_f32 v36, v24, v25
    v_cvt_pk_bf16_f32 v37, v26, v27
    v_cvt_pk_bf16_f32 v38, v28, v29
    v_cvt_pk_bf16_f32 v39, v30, v31
    s_waitcnt lgkmcnt(0)
    v_mfma_f32_16x16x32_bf16 v[84:87], a[128:131], v[32:35], 0
    v_mfma_f32_16x16x32_bf16 v[88:91], a[136:139], v[32:35], 0
    v_mfma_f32_16x16x32_bf16 v[84:87], a[132:135], v[36:39], v[84:87]
    v_mfma_f32_16x16x32_bf16 v[88:91], a[140:143], v[36:39], v[88:91]
    v_lshlrev_b32 v196, 16, v204
    v_and_b32 v197, 0xffff0000, v204
    v_lshlrev_b32 v198, 16, v205
    v_and_b32 v199, 0xffff0000, v205
    v_lshlrev_b32 v200, 16, v206
    v_and_b32 v201, 0xffff0000, v206
    v_lshlrev_b32 v202, 16, v207
    v_and_b32 v203, 0xffff0000, v207
    v_cvt_pk_bf16_f32 v116, v84, v85
    v_cvt_pk_bf16_f32 v118, v86, v87
    v_cndmask_b32 v116, v116, v118, s[44:45]
    v_cvt_pk_bf16_f32 v117, v88, v89
    v_cvt_pk_bf16_f32 v118, v90, v91
    v_cndmask_b32 v117, v117, v118, s[44:45]
    buffer_store_dwordx2 v[116:117], v221, s[40:43], s62 offen offset:0
    v_mul_f32 v108, v196, v196
    v_add_f32 v109, v196, v197
    v_fmac_f32 v108, v197, v197
    v_fmac_f32 v108, v198, v198
    v_add_f32 v109, v109, v198
    v_fmac_f32 v108, v199, v199
    v_add_f32 v109, v109, v199
    v_fmac_f32 v108, v200, v200
    v_add_f32 v109, v109, v200
    v_fmac_f32 v108, v201, v201
    v_add_f32 v109, v109, v201
    v_fmac_f32 v108, v202, v202
    v_add_f32 v109, v109, v202
    v_fmac_f32 v108, v203, v203
    v_add_f32 v109, v109, v203
    s_nop 0
    v_add_f32_dpp v108, v108, v108 quad_perm:[1,0,3,2] row_mask:0xf bank_mask:0xf
    v_add_f32_dpp v109, v109, v109 quad_perm:[1,0,3,2] row_mask:0xf bank_mask:0xf
    s_nop 0
    v_add_f32_dpp v108, v108, v108 quad_perm:[2,3,0,1] row_mask:0xf bank_mask:0xf
    v_add_f32_dpp v109, v109, v109 quad_perm:[2,3,0,1] row_mask:0xf bank_mask:0xf
    s_nop 0
    v_add_f32_dpp v108, v108, v108 row_half_mirror row_mask:0xf bank_mask:0xf
    v_add_f32_dpp v109, v109, v109 row_half_mirror row_mask:0xf bank_mask:0xf
    s_nop 0
    v_add_f32_dpp v108, v108, v108 row_mirror row_mask:0xf bank_mask:0xf
    v_add_f32_dpp v109, v109, v109 row_mirror row_mask:0xf bank_mask:0xf
    s_nop 0
    v_add_f32_dpp v108, v108, v108 row_bcast:15 row_mask:0xa bank_mask:0xf
    v_add_f32_dpp v109, v109, v109 row_bcast:15 row_mask:0xa bank_mask:0xf
    s_nop 0
    v_add_f32_dpp v108, v108, v108 row_bcast:31 row_mask:0xc bank_mask:0xf
    v_add_f32_dpp v109, v109, v109 row_bcast:31 row_mask:0xc bank_mask:0xf
    v_readlane_b32 s56, v108, 63
    v_readlane_b32 s57, v109, 63
    v_mov_b32 v119, 0x80808080
    v_mov_b32 v108, s56
    v_mov_b32 v109, s57
    v_mul_f32 v110, 0xbb000000, v109
    v_fmamk_f32 v108, v108, 0x3b000000, v15
    v_fma_f32 v108, -v110, v110, v108
    v_max_f32 v108, v108, v15
    v_rsq_f32 v111, v108
    s_nop 0
    v_mul_f32 v111, 0x3e0293ee, v111
    s_lshl_b32 s56, s52, 3
    s_lshl_b32 s57, s53, 5
    v_lshl_add_u32 v216, v0, 2, s56
    v_lshl_add_u32 v217, v0, 2, s57
    v_cmp_gt_u32 vcc, 2, v0
    s_nop 1
    v_cndmask_b32 v115, v212, v216, vcc
    v_lshl_add_u32 v217, v0, 3, s57
    s_cmp_eq_u32 s54, 0
    s_cselect_b32 s3, 15, 0
    v_cmp_gt_u32 vcc, 4, v0
    s_nop 1
    v_cndmask_b32 v119, v212, v217, vcc
    v_lshrrev_b32 v216, 1, v2
    v_mul_u32_u24 v216, 1040, v216
    v_mul_u32_u24 v217, 384, v215
    v_lshl_add_u32 v217, v3, 4, v217
    v_add3_u32 v112, v216, v217, s55
    v_xor_b32 v217, 128, v217
    v_add3_u32 v113, v216, v217, s55
    v_mul_u32_u24 v216, 1088, v3
    v_lshl_add_u32 v216, v213, 7, v216
    v_lshl_add_u32 v216, v215, 3, v216
    v_and_b32 v217, 2, v0
    v_lshl_add_u32 v216, v217, 4, v216
    s_lshl_b32 s56, s54, 6
    s_add_u32 s56, s56, 16384
    v_add_u32 v64, s56, v216
    v_add_u32 v65, 66560, v64
    s_mov_b64 exec, 1
    buffer_load_dword v227, v61, s[24:27], 0 offen
    buffer_load_dword v228, v7, s[28:31], 0 offen
    buffer_load_dword v229, v11, s[32:35], 0 offen
    s_mov_b64 exec, -1
    s_waitcnt vmcnt(11)
    s_add_u32 m0, s55, 11440
    s_mov_b32 s58, 53248
    buffer_load_dwordx4 v5, s[8:11], s58 offen nt lds
    s_waitcnt vmcnt(11)
    s_add_u32 m0, s55, 12480
    s_mov_b32 s58, 69632
    buffer_load_dwordx4 v5, s[8:11], s58 offen nt lds
    s_waitcnt vmcnt(11)
    s_add_u32 m0, s55, 13520
    s_mov_b32 s58, 86016
    buffer_load_dwordx4 v5, s[8:11], s58 offen nt lds
    s_waitcnt vmcnt(11)
    s_add_u32 m0, s55, 14560
    s_mov_b32 s58, 102400
    buffer_load_dwordx4 v5, s[8:11], s58 offen nt lds
    s_waitcnt lgkmcnt(0)
    ds_read_b128 a[0:3], v112 offset:0
    ds_read_b128 a[4:7], v112 offset:64
    ds_read_b128 a[8:11], v113 offset:0
    ds_read_b128 a[12:15], v113 offset:64
    ds_read_b128 a[32:35], v112 offset:512
    ds_read_b128 a[36:39], v112 offset:576
    ds_read_b128 a[40:43], v113 offset:512
    ds_read_b128 a[44:47], v113 offset:576
    s_waitcnt vmcnt(11)
    s_add_u32 m0, s55, 15600
    s_mov_b32 s58, 118784
    buffer_load_dwordx4 v5, s[8:11], s58 offen nt lds
    s_waitcnt vmcnt(11)
    s_add_u32 m0, s55, 16640
    s_mov_b32 s58, 8192
    buffer_load_dwordx4 v5, s[8:11], s58 offen nt lds
    buffer_load_dword v114, v115, s[36:39], 0 offen sc1
    s_waitcnt vmcnt(11)
    s_add_u32 m0, s55, 17680
    s_mov_b32 s58, 24576
    buffer_load_dwordx4 v5, s[8:11], s58 offen nt lds
    s_waitcnt vmcnt(11)
    s_add_u32 m0, s55, 18720
    s_mov_b32 s58, 40960
    buffer_load_dwordx4 v5, s[8:11], s58 offen nt lds
    s_waitcnt vmcnt(11)
    s_add_u32 m0, s55, 19760
    s_mov_b32 s58, 57344
    buffer_load_dwordx4 v5, s[8:11], s58 offen nt lds
    s_waitcnt vmcnt(11)
    s_add_u32 m0, s55, 20800
    s_mov_b32 s58, 73728
    buffer_load_dwordx4 v5, s[8:11], s58 offen nt lds
    s_waitcnt vmcnt(11)
    s_add_u32 m0, s55, 21840
    s_mov_b32 s58, 90112
    buffer_load_dwordx4 v5, s[8:11], s58 offen nt lds
    s_waitcnt vmcnt(11)
    s_add_u32 m0, s55, 22880
    s_mov_b32 s58, 106496
    buffer_load_dwordx4 v5, s[8:11], s58 offen nt lds
    s_waitcnt vmcnt(11)
    s_add_u32 m0, s55, 23920
    s_mov_b32 s58, 122880
    buffer_load_dwordx4 v5, s[8:11], s58 offen nt lds
    s_waitcnt vmcnt(11)
    s_add_u32 m0, s55, 24960
    s_mov_b32 s58, 12288
    buffer_load_dwordx4 v5, s[8:11], s58 offen nt lds
    s_waitcnt vmcnt(11)
    s_add_u32 m0, s55, 26000
    s_mov_b32 s58, 28672
    buffer_load_dwordx4 v5, s[8:11], s58 offen nt lds
    s_waitcnt vmcnt(11)
    s_add_u32 m0, s55, 27040
    s_mov_b32 s58, 45056
    buffer_load_dwordx4 v5, s[8:11], s58 offen nt lds
    s_waitcnt lgkmcnt(0)
    ds_read_b128 a[16:19], v112 offset:8320
    ds_read_b128 a[20:23], v112 offset:8384
    ds_read_b128 a[24:27], v113 offset:8320
    ds_read_b128 a[28:31], v113 offset:8384
    ds_read_b128 a[48:51], v112 offset:8832
    ds_read_b128 a[52:55], v112 offset:8896
    ds_read_b128 a[56:59], v113 offset:8832
    ds_read_b128 a[60:63], v113 offset:8896
    s_waitcnt vmcnt(11)
    s_add_u32 m0, s55, 28080
    s_mov_b32 s58, 61440
    buffer_load_dwordx4 v5, s[8:11], s58 offen nt lds
    s_waitcnt vmcnt(11)
    s_add_u32 m0, s55, 29120
    s_mov_b32 s58, 77824
    buffer_load_dwordx4 v5, s[8:11], s58 offen nt lds
    s_cmp_lg_u32 s54, 0
    s_cbranch_scc1 L_chk_done
    s_mul_i32 s61, s61, 0x01010101
L_chk:
    v_readlane_b32 s57, v114, 0
    v_readlane_b32 s56, v114, 1
    s_and_b32 s46, s56, s57
    s_andn2_b32 s46, 0x80808080, s46
    s_cbranch_scc1 L_chk_retry
    s_xor_b32 s56, s56, s61
    s_xor_b32 s57, s57, s61
    s_or_b32 s46, s56, s57
    s_andn2_b32 s46, s46, 64
    s_cbranch_scc1 L_chk_far
L_chk_ok:
    v_mov_b32 v114, s46
    ds_write_b32 v46, v114 offset:16
    s_waitcnt lgkmcnt(0)
L_chk_done:
    s_barrier
    ds_read_b32 v115, v46 offset:16
    buffer_load_dwordx4 v[100:103], v9, s[40:43], s62 offen offset:0 sc1
    buffer_load_dwordx4 v[104:107], v9, s[40:43], s62 offen offset:64 sc1
    buffer_load_dwordx4 v[120:123], v9, s[40:43], s63 offen offset:2048 sc1
    buffer_load_dwordx4 v[124:127], v9, s[40:43], s63 offen offset:2112 sc1
    s_or_b32 s56, s54, s53
    s_cbranch_scc0 L_team
L_team_done:
    s_waitcnt vmcnt(11)
    s_add_u32 m0, s55, 30160
    s_mov_b32 s58, 94208
    buffer_load_dwordx4 v5, s[8:11], s58 offen nt lds
    s_waitcnt vmcnt(11)
    s_add_u32 m0, s55, 31200
    s_mov_b32 s58, 110592
    buffer_load_dwordx4 v5, s[8:11], s58 offen nt lds
    s_waitcnt vmcnt(11)
    s_add_u32 m0, s55, 32240
    s_mov_b32 s58, 126976
    buffer_load_dwordx4 v5, s[8:11], s58 offen nt lds
    s_waitcnt lgkmcnt(0)
    ds_read_b128 a[64:67], v112 offset:16640
    ds_read_b128 a[68:71], v112 offset:16704
    ds_read_b128 a[72:75], v113 offset:16640
    ds_read_b128 a[76:79], v113 offset:16704
    ds_read_b128 a[96:99], v112 offset:17152
    ds_read_b128 a[100:103], v112 offset:17216
    ds_read_b128 a[104:107], v113 offset:17152
    ds_read_b128 a[108:111], v113 offset:17216
    s_waitcnt vmcnt(11)
    s_mov_b32 s58, 0
    buffer_load_dwordx4 v[128:131], v4, s[12:15], s58 offen nt
    s_waitcnt vmcnt(11)
    s_mov_b32 s58, 4096
    buffer_load_dwordx4 v[136:139], v4, s[12:15], s58 offen nt
    s_waitcnt vmcnt(11)
    s_mov_b32 s58, 8192
    buffer_load_dwordx4 v[132:135], v4, s[12:15], s58 offen nt
    s_waitcnt vmcnt(11)
    s_mov_b32 s58, 12288
    buffer_load_dwordx4 v[140:143], v4, s[12:15], s58 offen nt
    s_waitcnt vmcnt(11)
    s_mov_b32 s58, 16384
    buffer_load_dwordx4 v[144:147], v4, s[12:15], s58 offen nt
    s_waitcnt vmcnt(11)
    s_mov_b32 s58, 20480
    buffer_load_dwordx4 v[152:155], v4, s[12:15], s58 offen nt
    s_waitcnt vmcnt(11)
    s_mov_b32 s58, 24576
    buffer_load_dwordx4 v[148:151], v4, s[12:15], s58 offen nt
    s_waitcnt vmcnt(11)
    s_mov_b32 s58, 28672
    buffer_load_dwordx4 v[156:159], v4, s[12:15], s58 offen nt
    s_waitcnt vmcnt(11)
    s_mov_b32 s58, 32768
    buffer_load_dwordx4 v[160:163], v4, s[12:15], s58 offen nt
    s_waitcnt vmcnt(11)
    s_mov_b32 s58, 36864
    buffer_load_dwordx4 v[168:171], v4, s[12:15], s58 offen nt
    s_waitcnt vmcnt(11)
    s_mov_b32 s58, 40960
    buffer_load_dwordx4 v[164:167], v4, s[12:15], s58 offen nt
    s_waitcnt vmcnt(11)
    s_mov_b32 s58, 45056
    buffer_load_dwordx4 v[172:175], v4, s[12:15], s58 offen nt
    s_waitcnt lgkmcnt(0)
    ds_read_b128 a[80:83], v112 offset:24960
    ds_read_b128 a[84:87], v112 offset:25024
    ds_read_b128 a[88:91], v113 offset:24960
    ds_read_b128 a[92:95], v113 offset:25024
    ds_read_b128 a[112:115], v112 offset:25472
    ds_read_b128 a[116:119], v112 offset:25536
    ds_read_b128 a[120:123], v113 offset:25472
    ds_read_b128 a[124:127], v113 offset:25536
    v_mov_b64 v[68:69], 0
    v_mov_b64 v[70:71], 0
    v_mov_b64 v[72:73], 0
    v_mov_b64 v[74:75], 0
    v_mov_b64 v[76:77], 0
    v_mov_b64 v[78:79], 0
    v_mov_b64 v[80:81], 0
    v_mov_b64 v[82:83], 0
    v_mov_b64 v[84:85], 0
    v_mov_b64 v[86:87], 0
    v_mov_b64 v[88:89], 0
    v_mov_b64 v[90:91], 0
    v_mov_b64 v[92:93], 0
    v_mov_b64 v[94:95], 0
    v_mov_b64 v[96:97], 0
    v_mov_b64 v[98:99], 0
    v_readfirstlane_b32 s46, v115
    s_cmp_lg_u32 s46, 0
    s_cbranch_scc1 L_q0_far
L_q0:
    v_max3_u32 v116, v100, v101, v102
    v_max3_u32 v116, v116, v103, v104
    v_max3_u32 v116, v116, v105, v106
    v_max3_u32 v116, v116, v107, v120
    v_max3_u32 v116, v116, v121, v122
    v_max3_u32 v116, v116, v123, v124
    v_max3_u32 v116, v116, v125, v126
    v_max_u32 v116, v116, v127
    v_cmp_lt_u32 vcc, s60, v116
    s_cbranch_vccnz L_q0_retry
    s_waitcnt vmcnt(11)
    s_mov_b32 s58, 49152
    buffer_load_dwordx4 v[176:179], v4, s[12:15], s58 offen nt
    s_waitcnt lgkmcnt(0)
    v_smfmac_f32_16x16x64_bf16 v[68:71], v[120:123], a[0:7], v12
    s_nop 2
    v_smfmac_f32_16x16x64_bf16 v[84:87], v[120:123], a[64:71], v12
    s_nop 2
    v_smfmac_f32_16x16x64_bf16 v[68:71], v[124:127], a[8:15], v12
    s_nop 2
    v_smfmac_f32_16x16x64_bf16 v[84:87], v[124:127], a[72:79], v12
    s_nop 2
    v_smfmac_f32_16x16x64_bf16 v[76:79], v[120:123], a[32:39], v12
    v_add_f32 v68, v68, v69
    v_add_f32 v70, v70, v71
    v_add_f32 v68, v68, v70
    v_smfmac_f32_16x16x64_bf16 v[92:95], v[120:123], a[96:103], v12
    v_add_f32 v84, v84, v85
    v_add_f32 v86, v86, v87
    v_add_f32 v84, v84, v86
    v_smfmac_f32_16x16x64_bf16 v[76:79], v[124:127], a[40:47], v12
    s_nop 0
    v_permlane32_swap_b32 v68, v84
    s_nop 0
    v_smfmac_f32_16x16x64_bf16 v[92:95], v[124:127], a[104:111], v12
    v_add_f32 v68, v68, v84
    s_nop 0
    s_nop 0
    s_waitcnt vmcnt(11)
    s_mov_b32 s58, 53248
    buffer_load_dwordx4 v[184:187], v4, s[12:15], s58 offen nt
    v_smfmac_f32_16x16x64_bf16 v[72:75], v[120:123], a[16:23], v12
    v_add_f32 v76, v76, v77
    v_add_f32 v78, v78, v79
    v_add_f32 v76, v76, v78
    v_smfmac_f32_16x16x64_bf16 v[88:91], v[120:123], a[80:87], v12
    v_add_f32 v92, v92, v93
    v_add_f32 v94, v94, v95
    v_add_f32 v92, v92, v94
    v_smfmac_f32_16x16x64_bf16 v[72:75], v[124:127], a[24:31], v12
    s_nop 0
    v_permlane32_swap_b32 v76, v92
    s_nop 0
    v_smfmac_f32_16x16x64_bf16 v[88:91], v[124:127], a[88:95], v12
    v_add_f32 v76, v76, v92
    s_nop 0
    s_nop 0
    v_smfmac_f32_16x16x64_bf16 v[80:83], v[120:123], a[48:55], v12
    v_add_f32 v72, v72, v73
    v_add_f32 v74, v74, v75
    v_add_f32 v72, v72, v74
    v_smfmac_f32_16x16x64_bf16 v[96:99], v[120:123], a[112:119], v12
    v_add_f32 v88, v88, v89
    v_add_f32 v90, v90, v91
    v_add_f32 v88, v88, v90
    v_smfmac_f32_16x16x64_bf16 v[80:83], v[124:127], a[56:63], v12
    v_permlane16_swap_b32 v68, v76
    v_permlane32_swap_b32 v72, v88
    s_nop 0
    v_smfmac_f32_16x16x64_bf16 v[96:99], v[124:127], a[120:127], v12
    s_nop 0
    v_add_f32 v40, v68, v76
    v_add_f32 v72, v72, v88
    s_nop 0
    v_add_f32 v80, v80, v81
    v_add_f32 v82, v82, v83
    v_add_f32 v80, v80, v82
    s_nop 0
    v_add_f32 v96, v96, v97
    v_add_f32 v98, v98, v99
    v_add_f32 v96, v96, v98
    s_nop 0
    s_nop 0
    v_permlane32_swap_b32 v80, v96
    v_add_f32 v80, v80, v96
    s_nop 0
    s_nop 0
    v_permlane16_swap_b32 v72, v80
    v_add_f32 v41, v72, v80
    s_waitcnt vmcnt(11)
    s_mov_b32 s58, 57344
    buffer_load_dwordx4 v[180:183], v4, s[12:15], s58 offen nt
    v_mov_b64 v[68:69], 0
    v_mov_b64 v[70:71], 0
    v_mov_b64 v[72:73], 0
    v_mov_b64 v[74:75], 0
    v_mov_b64 v[76:77], 0
    v_mov_b64 v[78:79], 0
    v_mov_b64 v[80:81], 0
    v_mov_b64 v[82:83], 0
    v_mov_b64 v[84:85], 0
    v_mov_b64 v[86:87], 0
    v_mov_b64 v[88:89], 0
    v_mov_b64 v[90:91], 0
    v_mov_b64 v[92:93], 0
    v_mov_b64 v[94:95], 0
    v_mov_b64 v[96:97], 0
    v_mov_b64 v[98:99], 0
    v_smfmac_f32_16x16x64_bf16 v[68:71], v[100:103], a[0:7], v12
    s_nop 2
    v_smfmac_f32_16x16x64_bf16 v[84:87], v[100:103], a[64:71], v12
    s_nop 2
    v_smfmac_f32_16x16x64_bf16 v[68:71], v[104:107], a[8:15], v12
    s_nop 2
    v_smfmac_f32_16x16x64_bf16 v[84:87], v[104:107], a[72:79], v12
    s_nop 2
    v_smfmac_f32_16x16x64_bf16 v[76:79], v[100:103], a[32:39], v12
    v_add_f32 v68, v68, v69
    v_add_f32 v70, v70, v71
    v_add_f32 v68, v68, v70
    v_smfmac_f32_16x16x64_bf16 v[92:95], v[100:103], a[96:103], v12
    v_add_f32 v84, v84, v85
    v_add_f32 v86, v86, v87
    v_add_f32 v84, v84, v86
    v_smfmac_f32_16x16x64_bf16 v[76:79], v[104:107], a[40:47], v12
    s_nop 0
    v_permlane32_swap_b32 v68, v84
    s_nop 0
    v_smfmac_f32_16x16x64_bf16 v[92:95], v[104:107], a[104:111], v12
    v_add_f32 v68, v68, v84
    s_nop 0
    s_nop 0
    s_waitcnt vmcnt(11)
    s_mov_b32 s58, 61440
    buffer_load_dwordx4 v[188:191], v4, s[12:15], s58 offen nt
    v_smfmac_f32_16x16x64_bf16 v[72:75], v[100:103], a[16:23], v12
    v_add_f32 v76, v76, v77
    v_add_f32 v78, v78, v79
    v_add_f32 v76, v76, v78
    v_smfmac_f32_16x16x64_bf16 v[88:91], v[100:103], a[80:87], v12
    v_add_f32 v92, v92, v93
    v_add_f32 v94, v94, v95
    v_add_f32 v92, v92, v94
    v_smfmac_f32_16x16x64_bf16 v[72:75], v[104:107], a[24:31], v12
    s_nop 0
    v_permlane32_swap_b32 v76, v92
    s_nop 0
    v_smfmac_f32_16x16x64_bf16 v[88:91], v[104:107], a[88:95], v12
    v_add_f32 v76, v76, v92
    s_nop 0
    s_nop 0
    v_smfmac_f32_16x16x64_bf16 v[80:83], v[100:103], a[48:55], v12
    v_add_f32 v72, v72, v73
    v_add_f32 v74, v74, v75
    v_add_f32 v72, v72, v74
    v_smfmac_f32_16x16x64_bf16 v[96:99], v[100:103], a[112:119], v12
    v_add_f32 v88, v88, v89
    v_add_f32 v90, v90, v91
    v_add_f32 v88, v88, v90
    v_smfmac_f32_16x16x64_bf16 v[80:83], v[104:107], a[56:63], v12
    v_permlane16_swap_b32 v68, v76
    v_permlane32_swap_b32 v72, v88
    s_nop 0
    v_smfmac_f32_16x16x64_bf16 v[96:99], v[104:107], a[120:127], v12
    s_nop 0
    v_add_f32 v112, v68, v76
    v_add_f32 v72, v72, v88
    s_nop 0
    v_add_f32 v80, v80, v81
    v_add_f32 v82, v82, v83
    v_add_f32 v80, v80, v82
    v_mul_f32 v118, v41, v110
    v_add_f32 v96, v96, v97
    v_add_f32 v98, v98, v99
    v_add_f32 v96, v96, v98
    v_mul_f32 v118, v118, v111
    v_fmac_f32 v112, v40, v110
    v_permlane32_swap_b32 v80, v96
    v_add_f32 v80, v80, v96
    v_mul_f32 v112, v112, v111
    s_nop 0
    v_permlane16_swap_b32 v72, v80
    v_add_f32 v113, v72, v80
    v_fma_f32 v113, v113, v111, v118
    s_waitcnt vmcnt(11)
    s_mov_b32 s58, 65536
    buffer_load_dwordx4 v[192:195], v4, s[12:15], s58 offen nt
    v_max_f32 v116, v112, v113
    v_mov_b64 v[68:69], 0
    v_mov_b64 v[70:71], 0
    v_max_f32_dpp v116, v116, v116 quad_perm:[1,0,3,2] row_mask:0xf bank_mask:0xf
    v_mov_b64 v[72:73], 0
    v_mov_b64 v[74:75], 0
    v_max_f32_dpp v116, v116, v116 quad_perm:[2,3,0,1] row_mask:0xf bank_mask:0xf
    s_nop 1
    v_max_f32_dpp v116, v116, v116 row_half_mirror row_mask:0xf bank_mask:0xf
    s_nop 1
    v_max_f32_dpp v116, v116, v116 row_mirror row_mask:0xf bank_mask:0xf
    s_nop 1
    v_max_f32_dpp v116, v116, v116 row_bcast:15 row_mask:0xa bank_mask:0xf
    s_nop 1
    v_max_f32_dpp v116, v116, v116 row_bcast:31 row_mask:0xc bank_mask:0xf
    ds_write_b32 v45, v116
    v_readlane_b32 s61, v116, 63
    s_nop 1
    v_subrev_f32 v112, s61, v112
    v_subrev_f32 v113, s61, v113
    v_exp_f32 v112, v112
    v_exp_f32 v113, v113
    v_cvt_pk_bf16_f32 v114, v112, v112
    v_cvt_pk_bf16_f32 v115, v113, v113
    v_add_f32 v117, v112, v113
    s_waitcnt vmcnt(11)
    s_mov_b32 s58, 69632
    buffer_load_dwordx4 v[200:203], v4, s[12:15], s58 offen nt
    v_add_f32_dpp v117, v117, v117 quad_perm:[1,0,3,2] row_mask:0xf bank_mask:0xf
    s_nop 1
    v_add_f32_dpp v117, v117, v117 quad_perm:[2,3,0,1] row_mask:0xf bank_mask:0xf
    s_nop 1
    v_add_f32_dpp v117, v117, v117 row_half_mirror row_mask:0xf bank_mask:0xf
    s_nop 1
    v_add_f32_dpp v117, v117, v117 row_mirror row_mask:0xf bank_mask:0xf
    s_nop 1
    v_add_f32_dpp v117, v117, v117 row_bcast:15 row_mask:0xa bank_mask:0xf
    s_nop 1
    v_add_f32_dpp v117, v117, v117 row_bcast:31 row_mask:0xc bank_mask:0xf
    v_and_b32_dpp v76, v114, v14 row_newbcast:0 row_mask:0xf bank_mask:0xf
    v_and_b32_dpp v77, v115, v14 row_newbcast:0 row_mask:0xf bank_mask:0xf
    v_and_b32_dpp v78, v114, v14 row_newbcast:1 row_mask:0xf bank_mask:0xf
    v_and_b32_dpp v79, v115, v14 row_newbcast:1 row_mask:0xf bank_mask:0xf
    s_cmp_lg_u32 s46, 0
    s_cbranch_scc1 L_ml_far
    buffer_store_dwordx2 v[116:117], v49, s[40:43], s63 offen offset:1792
L_ml:
    s_waitcnt vmcnt(11)
    s_mov_b32 s58, 73728
    buffer_load_dwordx4 v[196:199], v4, s[12:15], s58 offen nt
    s_waitcnt lgkmcnt(0)
    s_barrier
    ds_read_b128 v[100:103], v46
    s_waitcnt lgkmcnt(0)
    v_max3_f32 v118, v100, v101, v102
    v_max_f32 v118, v118, v103
    v_sub_f32 v100, v100, v118
    v_sub_f32 v101, v101, v118
    v_sub_f32 v102, v102, v118
    v_sub_f32 v103, v103, v118
    v_exp_f32 v100, v100
    v_exp_f32 v101, v101
    v_exp_f32 v102, v102
    v_exp_f32 v103, v103
    s_waitcnt vmcnt(11)
    s_mov_b32 s58, 77824
    buffer_load_dwordx4 v[204:207], v4, s[12:15], s58 offen nt
    v_swap_b32 v130, v136
    v_swap_b32 v131, v137
    v_swap_b32 v134, v140
    v_swap_b32 v135, v141
    s_nop 1
    v_smfmac_f32_16x16x64_bf16 v[68:71], v[76:79], v[128:135], v13
    v_and_b32_dpp v80, v114, v14 row_newbcast:2 row_mask:0xf bank_mask:0xf
    v_and_b32_dpp v81, v115, v14 row_newbcast:2 row_mask:0xf bank_mask:0xf
    s_nop 0
    v_smfmac_f32_16x16x64_bf16 v[72:75], v[76:79], v[136:143], v13
    v_and_b32_dpp v82, v114, v14 row_newbcast:3 row_mask:0xf bank_mask:0xf
    v_and_b32_dpp v83, v115, v14 row_newbcast:3 row_mask:0xf bank_mask:0xf
    v_swap_b32 v146, v152
    v_swap_b32 v147, v153
    v_swap_b32 v150, v156
    v_swap_b32 v151, v157
    s_nop 1
    v_smfmac_f32_16x16x64_bf16 v[68:71], v[80:83], v[144:151], v13
    v_and_b32_dpp v76, v114, v14 row_newbcast:4 row_mask:0xf bank_mask:0xf
    v_and_b32_dpp v77, v115, v14 row_newbcast:4 row_mask:0xf bank_mask:0xf
    s_nop 0
    v_smfmac_f32_16x16x64_bf16 v[72:75], v[80:83], v[152:159], v13
    v_and_b32_dpp v78, v114, v14 row_newbcast:5 row_mask:0xf bank_mask:0xf
    v_and_b32_dpp v79, v115, v14 row_newbcast:5 row_mask:0xf bank_mask:0xf
    s_waitcnt vmcnt(11)
    s_mov_b32 s58, 81920
    buffer_load_dwordx4 v[208:211], v4, s[12:15], s58 offen nt
    buffer_load_dword v120, v119, s[36:39], 0 offen sc1
    s_waitcnt vmcnt(11)
    s_mov_b32 s58, 86016
    buffer_load_dwordx4 v[216:219], v4, s[12:15], s58 offen nt
    v_swap_b32 v162, v168
    v_swap_b32 v163, v169
    v_swap_b32 v166, v172
    v_swap_b32 v167, v173
    s_nop 1
    v_smfmac_f32_16x16x64_bf16 v[68:71], v[76:79], v[160:167], v13
    v_and_b32_dpp v80, v114, v14 row_newbcast:6 row_mask:0xf bank_mask:0xf
    v_and_b32_dpp v81, v115, v14 row_newbcast:6 row_mask:0xf bank_mask:0xf
    s_nop 0
    v_smfmac_f32_16x16x64_bf16 v[72:75], v[76:79], v[168:175], v13
    v_and_b32_dpp v82, v114, v14 row_newbcast:7 row_mask:0xf bank_mask:0xf
    v_and_b32_dpp v83, v115, v14 row_newbcast:7 row_mask:0xf bank_mask:0xf
    s_waitcnt vmcnt(11)
    s_mov_b32 s58, 90112
    buffer_load_dwordx4 v[212:215], v4, s[12:15], s58 offen nt
    s_waitcnt vmcnt(11)
    s_mov_b32 s58, 94208
    buffer_load_dwordx4 v[220:223], v4, s[12:15], s58 offen nt
    s_waitcnt vmcnt(11)
    s_mov_b32 s58, 98304
    buffer_load_dwordx4 v[224:227], v4, s[12:15], s58 offen nt
    s_waitcnt vmcnt(11)
    s_mov_b32 s58, 102400
    buffer_load_dwordx4 v[232:235], v4, s[12:15], s58 offen nt
    v_swap_b32 v178, v184
    v_swap_b32 v179, v185
    v_swap_b32 v182, v188
    v_swap_b32 v183, v189
    s_nop 1
    v_smfmac_f32_16x16x64_bf16 v[68:71], v[80:83], v[176:183], v13
    v_and_b32_dpp v76, v114, v14 row_newbcast:8 row_mask:0xf bank_mask:0xf
    v_and_b32_dpp v77, v115, v14 row_newbcast:8 row_mask:0xf bank_mask:0xf
    s_nop 0
    v_smfmac_f32_16x16x64_bf16 v[72:75], v[80:83], v[184:191], v13
    v_and_b32_dpp v78, v114, v14 row_newbcast:9 row_mask:0xf bank_mask:0xf
    v_and_b32_dpp v79, v115, v14 row_newbcast:9 row_mask:0xf bank_mask:0xf
    s_waitcnt vmcnt(11)
    s_mov_b32 s58, 106496
    buffer_load_dwordx4 v[228:231], v4, s[12:15], s58 offen nt
    s_waitcnt vmcnt(11)
    s_mov_b32 s58, 110592
    buffer_load_dwordx4 v[236:239], v4, s[12:15], s58 offen nt
    s_waitcnt vmcnt(11)
    s_mov_b32 s58, 114688
    buffer_load_dwordx4 v[240:243], v4, s[12:15], s58 offen nt
    s_waitcnt vmcnt(11)
    s_mov_b32 s58, 118784
    buffer_load_dwordx4 v[248:251], v4, s[12:15], s58 offen nt
    s_waitcnt vmcnt(11)
    s_mov_b32 s58, 122880
    buffer_load_dwordx4 v[244:247], v4, s[12:15], s58 offen nt
    v_swap_b32 v194, v200
    v_swap_b32 v195, v201
    v_swap_b32 v198, v204
    v_swap_b32 v199, v205
    s_nop 1
    v_smfmac_f32_16x16x64_bf16 v[68:71], v[76:79], v[192:199], v13
    v_and_b32_dpp v80, v114, v14 row_newbcast:10 row_mask:0xf bank_mask:0xf
    v_and_b32_dpp v81, v115, v14 row_newbcast:10 row_mask:0xf bank_mask:0xf
    s_nop 0
    v_smfmac_f32_16x16x64_bf16 v[72:75], v[76:79], v[200:207], v13
    v_and_b32_dpp v82, v114, v14 row_newbcast:11 row_mask:0xf bank_mask:0xf
    v_and_b32_dpp v83, v115, v14 row_newbcast:11 row_mask:0xf bank_mask:0xf
    s_waitcnt vmcnt(11)
    s_mov_b32 s58, 126976
    buffer_load_dwordx4 v[252:255], v4, s[12:15], s58 offen nt
    s_waitcnt vmcnt(11)
    s_add_u32 m0, s55, 16384
    s_mov_b32 s58, 0
    buffer_load_dwordx4 v6, s[20:23], s58 offen nt lds
L_all:
    v_and_b32 v120, 64, v120
    v_cmp_eq_u32 vcc, 0, v120
    s_and_b32 s56, vcc_lo, s3
    s_cbranch_scc1 L_all_retry
L_all_ok:
    s_waitcnt vmcnt(11)
    s_add_u32 m0, s55, 17472
    s_mov_b32 s58, 8192
    buffer_load_dwordx4 v6, s[20:23], s58 offen nt lds
    s_waitcnt vmcnt(11)
    s_add_u32 m0, s55, 18560
    s_mov_b32 s58, 16384
    buffer_load_dwordx4 v6, s[20:23], s58 offen nt lds
    s_waitcnt vmcnt(11)
    s_add_u32 m0, s55, 19648
    s_mov_b32 s58, 24576
    buffer_load_dwordx4 v6, s[20:23], s58 offen nt lds
    v_swap_b32 v210, v216
    v_swap_b32 v211, v217
    v_swap_b32 v214, v220
    v_swap_b32 v215, v221
    s_nop 1
    v_smfmac_f32_16x16x64_bf16 v[68:71], v[80:83], v[208:215], v13
    v_and_b32_dpp v76, v114, v14 row_newbcast:12 row_mask:0xf bank_mask:0xf
    v_and_b32_dpp v77, v115, v14 row_newbcast:12 row_mask:0xf bank_mask:0xf
    s_nop 0
    v_smfmac_f32_16x16x64_bf16 v[72:75], v[80:83], v[216:223], v13
    v_and_b32_dpp v78, v114, v14 row_newbcast:13 row_mask:0xf bank_mask:0xf
    v_and_b32_dpp v79, v115, v14 row_newbcast:13 row_mask:0xf bank_mask:0xf
    s_cmp_lg_u32 s46, 0
    s_cbranch_scc1 L_far
    s_waitcnt vmcnt(8)
    v_swap_b32 v226, v232
    v_swap_b32 v227, v233
    v_swap_b32 v230, v236
    v_swap_b32 v231, v237
    s_nop 1
    v_smfmac_f32_16x16x64_bf16 v[68:71], v[76:79], v[224:231], v13
    v_and_b32_dpp v80, v114, v14 row_newbcast:14 row_mask:0xf bank_mask:0xf
    v_and_b32_dpp v81, v115, v14 row_newbcast:14 row_mask:0xf bank_mask:0xf
    s_nop 0
    v_smfmac_f32_16x16x64_bf16 v[72:75], v[76:79], v[232:239], v13
    v_and_b32_dpp v82, v114, v14 row_newbcast:15 row_mask:0xf bank_mask:0xf
    v_and_b32_dpp v83, v115, v14 row_newbcast:15 row_mask:0xf bank_mask:0xf
    s_waitcnt vmcnt(4)
    v_swap_b32 v242, v248
    v_swap_b32 v243, v249
    v_swap_b32 v246, v252
    v_swap_b32 v247, v253
    s_nop 1
    v_smfmac_f32_16x16x64_bf16 v[68:71], v[80:83], v[240:247], v13
    s_cmp_ge_u32 s54, 2
    s_nop 1
    v_smfmac_f32_16x16x64_bf16 v[72:75], v[80:83], v[248:255], v13
    s_mov_b64 exec, 0xffff
    s_nop 2
    ds_write_b128 v44, v[68:71]
    s_nop 2
    ds_write_b128 v44, v[72:75] offset:16
    s_mov_b64 exec, -1
    s_waitcnt lgkmcnt(0)
    s_barrier
    s_cbranch_scc1 L_w0n
    ds_read2st64_b64 v[68:71], v47 offset0:0 offset1:1
    ds_read2st64_b64 v[72:75], v47 offset0:2 offset1:3
    buffer_load_dwordx4 v[108:111], v50, s[40:43], s63 offen offset:1792 sc1
    v_mov_b64 v[76:77], 0
    v_mov_b64 v[78:79], 0
    v_mov_b64 v[80:81], 0
    v_mov_b64 v[82:83], 0
    s_waitcnt lgkmcnt(1)
    v_pk_mul_f32 v[68:69], v[68:69], v[100:101] op_sel_hi:[1,0]
    v_pk_fma_f32 v[68:69], v[70:71], v[100:101], v[68:69] op_sel:[0,1,0]
    s_waitcnt lgkmcnt(0)
    v_pk_fma_f32 v[68:69], v[72:73], v[102:103], v[68:69] op_sel_hi:[1,0,1]
    v_pk_fma_f32 v[68:69], v[74:75], v[102:103], v[68:69] op_sel:[0,1,0]
    v_cvt_pk_bf16_f32 v68, v68, v69
    buffer_store_dword v68, v48, s[40:43], s62 offen offset:2048
    buffer_load_dwordx4 v[100:103], v9, s[40:43], s62 offen offset:2048 sc1
    buffer_load_dwordx4 v[104:107], v9, s[40:43], s62 offen offset:2112 sc1
    s_waitcnt vmcnt(3)
    s_barrier
    ds_read_b64_tr_b16 a[144:145], v64 offset:0
    ds_read_b64_tr_b16 a[146:147], v64 offset:512
    ds_read_b64_tr_b16 a[148:149], v64 offset:33280
    ds_read_b64_tr_b16 a[150:151], v64 offset:33792
    ds_read_b64_tr_b16 a[160:161], v64 offset:16
    ds_read_b64_tr_b16 a[162:163], v64 offset:528
    ds_read_b64_tr_b16 a[164:165], v64 offset:33296
    ds_read_b64_tr_b16 a[166:167], v64 offset:33808
    s_waitcnt lgkmcnt(6)
    ds_read_b64_tr_b16 a[152:153], v65 offset:0
    ds_read_b64_tr_b16 a[154:155], v65 offset:512
    ds_read_b64_tr_b16 a[156:157], v65 offset:33280
    ds_read_b64_tr_b16 a[158:159], v65 offset:33792
    ds_read_b64_tr_b16 a[168:169], v65 offset:16
    ds_read_b64_tr_b16 a[170:171], v65 offset:528
    ds_read_b64_tr_b16 a[172:173], v65 offset:33296
    ds_read_b64_tr_b16 a[174:175], v65 offset:33808
L_m0n:
    v_max_f32 v113, v108, v110
    v_max3_u32 v112, v108, v109, v110
    v_max_u32 v112, v112, v111
    v_max_f32_dpp v113, v113, v113 quad_perm:[1,0,3,2] row_mask:0xf bank_mask:0xf
    v_cmp_lt_u32 vcc, s60, v112
    s_cbranch_vccnz L_mr0n
    v_max_f32_dpp v114, v113, v113 quad_perm:[2,3,0,1] row_mask:0xf bank_mask:0xf
    s_nop 1
    v_max_f32_dpp v114, v114, v114 row_half_mirror row_mask:0xf bank_mask:0xf
    s_nop 1
    v_max_f32_dpp v114, v114, v114 row_mirror row_mask:0xf bank_mask:0xf
    v_sub_f32 v108, v108, v114
    v_sub_f32 v110, v110, v114
    v_exp_f32 v108, v108
    v_exp_f32 v110, v110
    v_mul_f32 v115, v108, v109
    v_fmac_f32 v115, v110, v111
    v_sub_f32 v113, v113, v114
    v_exp_f32 v113, v113
    v_add_f32_dpp v115, v115, v115 quad_perm:[1,0,3,2] row_mask:0xf bank_mask:0xf
    s_nop 1
    v_add_f32_dpp v115, v115, v115 quad_perm:[2,3,0,1] row_mask:0xf bank_mask:0xf
    s_nop 1
    v_add_f32_dpp v115, v115, v115 row_half_mirror row_mask:0xf bank_mask:0xf
    s_nop 1
    v_add_f32_dpp v115, v115, v115 row_mirror row_mask:0xf bank_mask:0xf
    v_rcp_f32 v115, v115
    s_nop 1
    v_mul_f32_dpp v114, v113, v115 row_newbcast:0 row_mask:0xf bank_mask:0xf
    v_mul_f32_dpp v113, v113, v115 row_newbcast:2 row_mask:0xf bank_mask:0xf
    v_cvt_pk_bf16_f32 v114, v114, v113
    v_cndmask_b32 v120, v114, 0, s[50:51]
    v_cndmask_b32 v121, v114, 0, s[50:51]
    v_cndmask_b32 v122, 0, v114, s[50:51]
    v_cndmask_b32 v123, 0, v114, s[50:51]
    s_branch L_o0n
L_mr0n:
    buffer_load_dwordx4 v[108:111], v50, s[40:43], s63 offen offset:1792 sc1
    buffer_load_dwordx4 v[100:103], v9, s[40:43], s62 offen offset:2048 sc1
    buffer_load_dwordx4 v[104:107], v9, s[40:43], s62 offen offset:2112 sc1
    s_add_u32 s59, s59, 0x10000
    s_cselect_b32 s60, -1, s60
    s_waitcnt vmcnt(2)
    s_branch L_m0n
L_s0n:
    s_nop 1
    v_mfma_f32_16x16x32_bf16 v[92:95], v[32:35], v[32:35], 0
    v_cvt_pk_bf16_f32 v36, v24, v25
    v_cvt_pk_bf16_f32 v37, v26, v27
    v_cvt_pk_bf16_f32 v38, v28, v29
    v_cvt_pk_bf16_f32 v39, v30, v31
    s_nop 1
    v_mfma_f32_16x16x32_bf16 v[92:95], v[36:39], v[36:39], v[92:95]
    s_nop 7
    buffer_store_dwordx2 v[92:93], v11, s[40:43], s63 offen offset:1664
    s_branch L_y0n
L_or0n:
    buffer_load_dwordx4 v[100:103], v9, s[40:43], s62 offen offset:2048 sc1
    buffer_load_dwordx4 v[104:107], v9, s[40:43], s62 offen offset:2112 sc1
    s_add_u32 s59, s59, 0x10000
    s_cselect_b32 s60, -1, s60
    s_nop 2
    v_mov_b64 v[76:77], 0
    v_mov_b64 v[78:79], 0
    v_mov_b64 v[80:81], 0
    v_mov_b64 v[82:83], 0
L_o0n:
    s_waitcnt vmcnt(1)
    s_waitcnt lgkmcnt(0)
    v_smfmac_f32_16x16x64_bf16 v[76:79], v[100:103], a[144:151], v12
    v_max3_u32 v112, v100, v101, v102
    s_waitcnt vmcnt(0)
    v_max3_u32 v112, v112, v103, v104
    v_smfmac_f32_16x16x64_bf16 v[80:83], v[100:103], a[160:167], v12
    v_max3_u32 v112, v112, v105, v106
    v_max_u32 v112, v112, v107
    v_cmp_lt_u32 vcc, s60, v112
    v_smfmac_f32_16x16x64_bf16 v[76:79], v[104:107], a[152:159], v12
    s_cbranch_vccnz L_or0n
    s_nop 1
    v_smfmac_f32_16x16x64_bf16 v[80:83], v[104:107], a[168:175], v12
    s_barrier
    s_nop 2
    v_cvt_pk_bf16_f32 v84, v76, v77
    v_cvt_pk_bf16_f32 v85, v78, v79
    s_nop 1
    v_cvt_pk_bf16_f32 v86, v80, v81
    v_cvt_pk_bf16_f32 v87, v82, v83
    s_nop 1
    v_mfma_f32_16x16x32_bf16 v[88:91], v[120:123], v[84:87], 0
    s_nop 7
    v_cvt_pk_bf16_f32 v88, v88, v89
    buffer_store_dword v88, v51, s[40:43], s66 offen offset:0 sc1
    buffer_store_dword v88, v51, s[40:43], s47 offen offset:0 sc1
    v_lshlrev_b32 v124, 6, v3
    v_sub_u32 v124, v64, v124
    v_add_u32 v65, 80384, v124
    v_lshrrev_b32 v124, 2, v1
    v_mul_u32_u24 v124, 96, v124
    v_and_b32 v125, 3, v0
    v_lshlrev_b32 v125, 3, v125
    s_lshl_b32 s56, s54, 5
    s_add_u32 s56, s56, 66560
    v_add3_u32 v64, v124, v125, s56
    s_mov_b64 vcc, -1
    s_waitcnt vmcnt(0)
L_g0n:
    s_mov_b64 exec, vcc
    buffer_load_dwordx4 v[100:103], v52, s[40:43], s66 offen offset:0 sc1
    buffer_load_dwordx4 v[104:107], v52, s[40:43], s66 offen offset:1024 sc1
    s_add_u32 s59, s59, 0x10000
    s_cselect_b32 s60, -1, s60
    s_waitcnt vmcnt(1)
    ds_write2_b64 v54, v[100:101], v[102:103] offset0:0 offset1:128
    v_max3_u32 v112, v100, v101, v102
    s_waitcnt vmcnt(0)
    ds_write2_b64 v54, v[104:105], v[106:107] offset0:32 offset1:160
    v_max3_u32 v112, v112, v103, v104
    v_max3_u32 v112, v112, v105, v106
    v_max_u32 v112, v112, v107
    v_cmp_lt_u32 vcc, s60, v112
    s_cbranch_vccnz L_g0n
    s_mov_b64 exec, -1
    s_waitcnt lgkmcnt(0)
L_x0n:
    s_cmp_eq_u32 s54, 3
    s_barrier
    ds_read_b64_tr_b16 v[68:69], v53 offset:0
    ds_read_b64_tr_b16 v[70:71], v53 offset:512
    ds_read_b64_tr_b16 v[72:73], v53 offset:1024
    ds_read_b64_tr_b16 v[74:75], v53 offset:1536
    ds_read_b64_tr_b16 v[76:77], v53 offset:2176
    ds_read_b64_tr_b16 v[78:79], v53 offset:2688
    ds_read_b64_tr_b16 v[80:81], v53 offset:3200
    ds_read_b64_tr_b16 v[82:83], v53 offset:3712
    ds_read_b64_tr_b16 a[176:177], v64 offset:0
    ds_read_b64_tr_b16 a[178:179], v64 offset:1536
    ds_read_b64_tr_b16 a[184:185], v64 offset:36352
    ds_read_b64_tr_b16 a[186:187], v64 offset:37888
    s_waitcnt lgkmcnt(10)
    v_mfma_f32_16x16x32_bf16 v[16:19], v[68:71], a[208:211], v[16:19]
    ds_read_b64_tr_b16 a[180:181], v64 offset:3072
    ds_read_b64_tr_b16 a[182:183], v64 offset:4608
    s_waitcnt lgkmcnt(10)
    v_mfma_f32_16x16x32_bf16 v[20:23], v[72:75], a[208:211], v[20:23]
    ds_read_b64_tr_b16 a[188:189], v64 offset:39424
    ds_read_b64_tr_b16 a[190:191], v64 offset:40960
    s_waitcnt lgkmcnt(10)
    v_mfma_f32_16x16x32_bf16 v[24:27], v[76:79], a[208:211], v[24:27]
    v_cvt_pk_bf16_f32 v32, v16, v17
    v_cvt_pk_bf16_f32 v33, v18, v19
    s_waitcnt lgkmcnt(8)
    v_mfma_f32_16x16x32_bf16 v[28:31], v[80:83], a[208:211], v[28:31]
    v_cvt_pk_bf16_f32 v34, v20, v21
    v_cvt_pk_bf16_f32 v35, v22, v23
    s_cbranch_scc1 L_s0n
    s_waitcnt lgkmcnt(4)
    v_mfma_f32_16x16x32_bf16 v[84:87], v[32:35], a[176:179], 0
    v_cvt_pk_bf16_f32 v36, v24, v25
    v_cvt_pk_bf16_f32 v37, v26, v27
    s_nop 0
    v_mfma_f32_16x16x32_bf16 v[88:91], v[32:35], a[184:187], 0
    v_cvt_pk_bf16_f32 v38, v28, v29
    v_cvt_pk_bf16_f32 v39, v30, v31
    s_waitcnt lgkmcnt(0)
    s_nop 0
    v_mfma_f32_16x16x32_bf16 v[84:87], v[36:39], a[180:183], v[84:87]
    s_nop 2
    v_mfma_f32_16x16x32_bf16 v[88:91], v[36:39], a[188:191], v[88:91]
    s_cmp_eq_u32 s54, 2
    s_nop 6
    v_cvt_pk_bf16_f32 v112, v84, v88
    buffer_store_dword v112, v55, s[40:43], s63 offen offset:0
    v_cvt_pk_bf16_f32 v113, v85, v89
    buffer_store_dword v113, v55, s[40:43], s65 offen offset:2048
    s_cbranch_scc1 L_y0n
    ds_read_b64_tr_b16 a[192:193], v65 offset:0
    ds_read_b64_tr_b16 a[194:195], v65 offset:512
    ds_read_b64_tr_b16 a[196:197], v65 offset:4096
    ds_read_b64_tr_b16 a[198:199], v65 offset:4608
    ds_read_b64_tr_b16 a[200:201], v65 offset:16
    ds_read_b64_tr_b16 a[202:203], v65 offset:528
    ds_read_b64_tr_b16 a[204:205], v65 offset:4112
    ds_read_b64_tr_b16 a[206:207], v65 offset:4624
    v_mov_b64 v[68:69], 0
    v_mov_b64 v[70:71], 0
    v_mov_b64 v[72:73], 0
    v_mov_b64 v[74:75], 0
L_c0n:
    buffer_load_dwordx4 v[108:111], v10, s[40:43], s63 offen offset:1664 sc1
    buffer_load_dwordx4 v[100:103], v56, s[40:43], s63 offen offset:0 sc1
    buffer_load_dwordx4 v[104:107], v56, s[40:43], s63 offen offset:16 sc1
    buffer_load_dwordx4 v[120:123], v56, s[40:43], s65 offen offset:2048 sc1
    buffer_load_dwordx4 v[124:127], v56, s[40:43], s65 offen offset:2064 sc1
    s_add_u32 s59, s59, 0x10000
    s_cselect_b32 s60, -1, s60
    s_waitcnt vmcnt(4)
    v_pk_add_f32 v[114:115], v[108:109], v[110:111]
    v_max3_u32 v112, v108, v109, v110
    s_waitcnt vmcnt(3)
    v_mfma_f32_16x16x32_bf16 v[76:79], a[212:215], v[100:103], 0
    v_add_f32_dpp v115, v115, v115 quad_perm:[1,0,3,2] row_mask:0xf bank_mask:0xf
    v_add_f32_dpp v114, v114, v114 quad_perm:[1,0,3,2] row_mask:0xf bank_mask:0xf
    v_max3_u32 v112, v112, v111, v100
    s_waitcnt vmcnt(2)
    v_mfma_f32_16x16x32_bf16 v[76:79], a[212:215], v[104:107], v[76:79]
    v_max3_u32 v112, v112, v101, v102
    v_max3_u32 v112, v112, v103, v104
    v_max3_u32 v112, v112, v105, v106
    s_waitcnt vmcnt(1)
    v_mfma_f32_16x16x32_bf16 v[80:83], a[212:215], v[120:123], 0
    v_max3_u32 v112, v112, v107, v120
    v_max3_u32 v112, v112, v121, v122
    s_waitcnt vmcnt(0)
    v_mfma_f32_16x16x32_bf16 v[80:83], a[212:215], v[124:127], v[80:83]
    v_max3_u32 v112, v112, v123, v124
    v_max3_u32 v112, v112, v125, v126
    v_max_u32 v112, v112, v127
    v_cmp_lt_u32 vcc, s60, v112
    v_add_f32_dpp v109, v115, v115 quad_perm:[2,3,0,1] row_mask:0xf bank_mask:0xf
    s_cbranch_vccnz L_c0n
    v_add_f32_dpp v108, v114, v114 quad_perm:[2,3,0,1] row_mask:0xf bank_mask:0xf
    v_mul_f32 v110, 0xbb000000, v109
    v_fmamk_f32 v108, v108, 0x3b000000, v15
    v_fma_f32 v108, -v110, v110, v108
    v_max_f32 v108, v108, v15
    v_rsq_f32 v112, v108
    v_pk_fma_f32 v[76:77], v[80:81], v[110:111], v[76:77] op_sel_hi:[1,0,1]
    v_mul_f32 v112, 0xbfb8aa3b, v112
    v_mul_f32 v112, v76, v112
    v_exp_f32 v112, v112
    v_mul_f32 v76, v76, v77
    v_fmac_f32 v108, v112, v108
    v_rcp_f32 v108, v108
    v_mov_b64 v[42:43], v[80:81]
    v_mul_f32 v76, v76, v108
    v_cvt_pk_bf16_f32 v76, v76, v76
    v_and_b32 v100, v76, v57
    v_and_b32 v101, v76, v58
    v_and_b32 v102, v76, v59
    v_and_b32 v103, v76, v60
    s_waitcnt lgkmcnt(0)
    s_nop 0
    v_smfmac_f32_16x16x64_bf16 v[68:71], v[100:103], a[192:199], v13
    s_nop 2
    v_smfmac_f32_16x16x64_bf16 v[72:75], v[100:103], a[200:207], v13
    s_nop 3
    v_cvt_pk_bf16_f32 v84, v68, v69
    v_cvt_pk_bf16_f32 v85, v70, v71
    s_nop 1
    v_cvt_pk_bf16_f32 v86, v72, v73
    v_cvt_pk_bf16_f32 v87, v74, v75
    s_nop 1
    v_mfma_f32_16x16x32_bf16 v[88:91], a[216:219], v[84:87], 0
    s_nop 7
    v_cvt_pk_bf16_f32 v88, v88, v89
    buffer_store_dword v88, v51, s[40:43], s67 offen offset:0 sc1
    buffer_store_dword v88, v51, s[40:43], s48 offen offset:0 sc1
    s_mov_b64 vcc, -1
    s_waitcnt vmcnt(0)
L_h0n:
    s_mov_b64 exec, vcc
    buffer_load_dwordx4 v[100:103], v52, s[40:43], s67 offen offset:0 sc1
    buffer_load_dwordx4 v[104:107], v52, s[40:43], s67 offen offset:1024 sc1
    s_add_u32 s59, s59, 0x10000
    s_cselect_b32 s60, -1, s60
    s_waitcnt vmcnt(1)
    ds_write2_b64 v54, v[100:101], v[102:103] offset0:0 offset1:128
    v_max3_u32 v112, v100, v101, v102
    s_waitcnt vmcnt(0)
    ds_write2_b64 v54, v[104:105], v[106:107] offset0:32 offset1:160
    v_max3_u32 v112, v112, v103, v104
    v_max3_u32 v112, v112, v105, v106
    v_max_u32 v112, v112, v107
    v_cmp_lt_u32 vcc, s60, v112
    s_cbranch_vccnz L_h0n
    s_mov_b64 exec, -1
    s_waitcnt lgkmcnt(0)
L_y0n:
    s_barrier
    ds_read_b64_tr_b16 v[68:69], v53 offset:0
    ds_read_b64_tr_b16 v[70:71], v53 offset:512
    ds_read_b64_tr_b16 v[72:73], v53 offset:1024
    ds_read_b64_tr_b16 v[74:75], v53 offset:1536
    ds_read_b64_tr_b16 v[76:77], v53 offset:2176
    ds_read_b64_tr_b16 v[78:79], v53 offset:2688
    ds_read_b64_tr_b16 v[80:81], v53 offset:3200
    ds_read_b64_tr_b16 v[82:83], v53 offset:3712
    s_waitcnt lgkmcnt(6)
    v_mfma_f32_16x16x32_bf16 v[16:19], v[68:71], a[208:211], v[16:19]
    s_waitcnt lgkmcnt(4)
    s_nop 1
    v_mfma_f32_16x16x32_bf16 v[20:23], v[72:75], a[208:211], v[20:23]
    s_waitcnt lgkmcnt(2)
    s_nop 1
    v_mfma_f32_16x16x32_bf16 v[24:27], v[76:79], a[208:211], v[24:27]
    v_cvt_pk_bf16_f32 v32, v16, v17
    v_cvt_pk_bf16_f32 v33, v18, v19
    s_waitcnt lgkmcnt(0)
    v_mfma_f32_16x16x32_bf16 v[28:31], v[80:83], a[208:211], v[28:31]
    v_cvt_pk_bf16_f32 v34, v20, v21
    v_cvt_pk_bf16_f32 v35, v22, v23
    s_nop 0
    s_nop 0
    v_mfma_f32_16x16x32_bf16 v[84:87], a[128:131], v[32:35], 0
    v_cvt_pk_bf16_f32 v36, v24, v25
    v_cvt_pk_bf16_f32 v37, v26, v27
    s_nop 0
    v_mfma_f32_16x16x32_bf16 v[88:91], a[136:139], v[32:35], 0
    v_cvt_pk_bf16_f32 v38, v28, v29
    v_cvt_pk_bf16_f32 v39, v30, v31
    s_nop 0
    s_nop 0
    v_mfma_f32_16x16x32_bf16 v[84:87], a[132:135], v[36:39], v[84:87]
    s_nop 2
    v_mfma_f32_16x16x32_bf16 v[88:91], a[140:143], v[36:39], v[88:91]
    s_nop 2
    v_mfma_f32_16x16x32_bf16 v[92:95], v[32:35], v[32:35], 0
    v_cvt_pk_bf16_f32 v116, v84, v85
    v_cvt_pk_bf16_f32 v118, v86, v87
    v_cndmask_b32 v116, v116, v118, s[44:45]
    v_mfma_f32_16x16x32_bf16 v[92:95], v[36:39], v[36:39], v[92:95]
    v_cvt_pk_bf16_f32 v117, v88, v89
    v_cvt_pk_bf16_f32 v118, v90, v91
    v_cndmask_b32 v117, v117, v118, s[44:45]
    buffer_store_dwordx2 v[116:117], v8, s[40:43], s64 offen offset:0
    s_nop 3
    buffer_store_dwordx2 v[92:93], v11, s[40:43], s65 offen offset:1536
L_q1n:
    buffer_load_dwordx4 v[100:103], v9, s[40:43], s64 offen offset:0 sc1
    buffer_load_dwordx4 v[104:107], v9, s[40:43], s64 offen offset:64 sc1
    buffer_load_dwordx4 v[108:111], v10, s[40:43], s65 offen offset:1536 sc1
    s_add_u32 s59, s59, 0x10000
    s_cselect_b32 s60, -1, s60
    v_mov_b64 v[72:73], 0
    v_mov_b64 v[74:75], 0
    v_mov_b64 v[76:77], 0
    v_mov_b64 v[78:79], 0
    v_mov_b64 v[80:81], 0
    v_mov_b64 v[82:83], 0
    v_mov_b64 v[96:97], 0
    v_mov_b64 v[98:99], 0
    v_mov_b64 v[88:89], 0
    v_mov_b64 v[90:91], 0
    v_mov_b64 v[92:93], 0
    v_mov_b64 v[94:95], 0
    v_mov_b64 v[68:69], 0
    v_mov_b64 v[70:71], 0
    v_mov_b64 v[84:85], 0
    v_mov_b64 v[86:87], 0
    s_waitcnt vmcnt(1)
    v_smfmac_f32_16x16x64_bf16 v[68:71], v[100:103], a[0:7], v12
    v_max3_u32 v112, v100, v101, v102
    v_max3_u32 v112, v112, v103, v104
    v_max3_u32 v112, v112, v105, v106
    v_smfmac_f32_16x16x64_bf16 v[84:87], v[100:103], a[64:71], v12
    v_max_u32 v112, v112, v107
    v_cmp_lt_u32 vcc, s60, v112
    s_cbranch_vccnz L_q1n
    v_smfmac_f32_16x16x64_bf16 v[68:71], v[104:107], a[8:15], v12
    s_waitcnt vmcnt(0)
    v_max3_u32 v112, v108, v109, v110
    v_max_u32 v112, v112, v111
    v_smfmac_f32_16x16x64_bf16 v[84:87], v[104:107], a[72:79], v12
    v_cmp_lt_u32 vcc, s60, v112
    s_cbranch_vccnz L_sr1n
L_sb1n:
    v_add_f32 v108, v108, v110
    v_smfmac_f32_16x16x64_bf16 v[76:79], v[100:103], a[32:39], v12
    v_add_f32 v68, v68, v69
    v_add_f32 v70, v70, v71
    v_add_f32 v68, v68, v70
    v_smfmac_f32_16x16x64_bf16 v[92:95], v[100:103], a[96:103], v12
    v_add_f32 v84, v84, v85
    v_add_f32 v86, v86, v87
    v_add_f32 v84, v84, v86
    v_smfmac_f32_16x16x64_bf16 v[76:79], v[104:107], a[40:47], v12
    v_add_f32 v109, v109, v111
    v_permlane32_swap_b32 v68, v84
    v_add_f32_dpp v108, v108, v108 quad_perm:[1,0,3,2] row_mask:0xf bank_mask:0xf
    v_smfmac_f32_16x16x64_bf16 v[92:95], v[104:107], a[104:111], v12
    v_add_f32 v68, v68, v84
    v_add_f32_dpp v109, v109, v109 quad_perm:[1,0,3,2] row_mask:0xf bank_mask:0xf
    v_add_f32_dpp v108, v108, v108 quad_perm:[2,3,0,1] row_mask:0xf bank_mask:0xf
    v_smfmac_f32_16x16x64_bf16 v[72:75], v[100:103], a[16:23], v12
    v_add_f32 v76, v76, v77
    v_add_f32 v78, v78, v79
    v_add_f32 v76, v76, v78
    v_smfmac_f32_16x16x64_bf16 v[88:91], v[100:103], a[80:87], v12
    v_add_f32 v92, v92, v93
    v_add_f32 v94, v94, v95
    v_add_f32 v92, v92, v94
    v_smfmac_f32_16x16x64_bf16 v[72:75], v[104:107], a[24:31], v12
    v_add_f32_dpp v109, v109, v109 quad_perm:[2,3,0,1] row_mask:0xf bank_mask:0xf
    v_permlane32_swap_b32 v76, v92
    v_fmamk_f32 v108, v108, 0x3b000000, v15
    v_smfmac_f32_16x16x64_bf16 v[88:91], v[104:107], a[88:95], v12
    v_add_f32 v76, v76, v92
    v_mul_f32 v110, 0xbb000000, v109
    v_fma_f32 v108, -v110, v110, v108
    v_smfmac_f32_16x16x64_bf16 v[80:83], v[100:103], a[48:55], v12
    v_add_f32 v72, v72, v73
    v_add_f32 v74, v74, v75
    v_add_f32 v72, v72, v74
    v_smfmac_f32_16x16x64_bf16 v[96:99], v[100:103], a[112:119], v12
    v_add_f32 v88, v88, v89
    v_add_f32 v90, v90, v91
    v_add_f32 v88, v88, v90
    v_smfmac_f32_16x16x64_bf16 v[80:83], v[104:107], a[56:63], v12
    v_permlane16_swap_b32 v68, v76
    v_permlane32_swap_b32 v72, v88
    v_max_f32 v108, v108, v15
    v_smfmac_f32_16x16x64_bf16 v[96:99], v[104:107], a[120:127], v12
    v_rsq_f32 v111, v108
    v_add_f32 v112, v68, v76
    v_add_f32 v72, v72, v88
    v_mul_f32 v111, 0x3e0293ee, v111
    v_add_f32 v80, v80, v81
    v_add_f32 v82, v82, v83
    v_add_f32 v80, v80, v82
    v_mul_f32 v118, v41, v110
    v_add_f32 v96, v96, v97
    v_add_f32 v98, v98, v99
    v_add_f32 v96, v96, v98
    v_mul_f32 v118, v118, v111
    v_fmac_f32 v112, v40, v110
    v_permlane32_swap_b32 v80, v96
    v_add_f32 v80, v80, v96
    v_mul_f32 v112, v112, v111
    s_nop 0
    v_permlane16_swap_b32 v72, v80
    v_add_f32 v113, v72, v80
    v_fma_f32 v113, v113, v111, v118
    v_max_f32 v116, v112, v113
    v_mov_b64 v[68:69], 0
    v_mov_b64 v[70:71], 0
    v_max_f32_dpp v116, v116, v116 quad_perm:[1,0,3,2] row_mask:0xf bank_mask:0xf
    v_mov_b64 v[72:73], 0
    v_mov_b64 v[74:75], 0
    v_max_f32_dpp v116, v116, v116 quad_perm:[2,3,0,1] row_mask:0xf bank_mask:0xf
    s_nop 1
    v_max_f32_dpp v116, v116, v116 row_half_mirror row_mask:0xf bank_mask:0xf
    s_nop 1
    v_max_f32_dpp v116, v116, v116 row_mirror row_mask:0xf bank_mask:0xf
    s_nop 1
    v_max_f32_dpp v116, v116, v116 row_bcast:15 row_mask:0xa bank_mask:0xf
    s_nop 1
    v_max_f32_dpp v116, v116, v116 row_bcast:31 row_mask:0xc bank_mask:0xf
    ds_write_b32 v45, v116
    v_readlane_b32 s61, v116, 63
    s_nop 1
    v_subrev_f32 v112, s61, v112
    v_subrev_f32 v113, s61, v113
    v_exp_f32 v112, v112
    v_exp_f32 v113, v113
    v_cvt_pk_bf16_f32 v114, v112, v112
    v_cvt_pk_bf16_f32 v115, v113, v113
    v_add_f32 v117, v112, v113
    v_and_b32_dpp v76, v114, v14 row_newbcast:0 row_mask:0xf bank_mask:0xf
    v_and_b32_dpp v78, v114, v14 row_newbcast:1 row_mask:0xf bank_mask:0xf
    v_and_b32_dpp v77, v115, v14 row_newbcast:0 row_mask:0xf bank_mask:0xf
    v_and_b32_dpp v79, v115, v14 row_newbcast:1 row_mask:0xf bank_mask:0xf
    v_and_b32_dpp v80, v114, v14 row_newbcast:2 row_mask:0xf bank_mask:0xf
    v_and_b32_dpp v81, v115, v14 row_newbcast:2 row_mask:0xf bank_mask:0xf
    v_smfmac_f32_16x16x64_bf16 v[68:71], v[76:79], v[128:135], v13
    v_and_b32_dpp v82, v114, v14 row_newbcast:3 row_mask:0xf bank_mask:0xf
    v_and_b32_dpp v83, v115, v14 row_newbcast:3 row_mask:0xf bank_mask:0xf
    v_add_f32_dpp v117, v117, v117 quad_perm:[1,0,3,2] row_mask:0xf bank_mask:0xf
    v_smfmac_f32_16x16x64_bf16 v[72:75], v[76:79], v[136:143], v13
    v_and_b32_dpp v76, v114, v14 row_newbcast:4 row_mask:0xf bank_mask:0xf
    v_and_b32_dpp v77, v115, v14 row_newbcast:4 row_mask:0xf bank_mask:0xf
    v_add_f32_dpp v117, v117, v117 quad_perm:[2,3,0,1] row_mask:0xf bank_mask:0xf
    v_smfmac_f32_16x16x64_bf16 v[68:71], v[80:83], v[144:151], v13
    v_and_b32_dpp v78, v114, v14 row_newbcast:5 row_mask:0xf bank_mask:0xf
    v_and_b32_dpp v79, v115, v14 row_newbcast:5 row_mask:0xf bank_mask:0xf
    s_waitcnt lgkmcnt(0)
    v_smfmac_f32_16x16x64_bf16 v[72:75], v[80:83], v[152:159], v13
    v_and_b32_dpp v80, v114, v14 row_newbcast:6 row_mask:0xf bank_mask:0xf
    v_and_b32_dpp v81, v115, v14 row_newbcast:6 row_mask:0xf bank_mask:0xf
    s_barrier
    v_smfmac_f32_16x16x64_bf16 v[68:71], v[76:79], v[160:167], v13
    v_and_b32_dpp v82, v114, v14 row_newbcast:7 row_mask:0xf bank_mask:0xf
    v_and_b32_dpp v83, v115, v14 row_newbcast:7 row_mask:0xf bank_mask:0xf
    ds_read_b128 v[100:103], v46
    v_smfmac_f32_16x16x64_bf16 v[72:75], v[76:79], v[168:175], v13
    v_and_b32_dpp v76, v114, v14 row_newbcast:8 row_mask:0xf bank_mask:0xf
    v_and_b32_dpp v77, v115, v14 row_newbcast:8 row_mask:0xf bank_mask:0xf
    v_add_f32_dpp v117, v117, v117 row_half_mirror row_mask:0xf bank_mask:0xf
    v_smfmac_f32_16x16x64_bf16 v[68:71], v[80:83], v[176:183], v13
    v_and_b32_dpp v78, v114, v14 row_newbcast:9 row_mask:0xf bank_mask:0xf
    v_and_b32_dpp v79, v115, v14 row_newbcast:9 row_mask:0xf bank_mask:0xf
    v_add_f32_dpp v117, v117, v117 row_mirror row_mask:0xf bank_mask:0xf
    v_smfmac_f32_16x16x64_bf16 v[72:75], v[80:83], v[184:191], v13
    v_and_b32_dpp v80, v114, v14 row_newbcast:10 row_mask:0xf bank_mask:0xf
    v_and_b32_dpp v81, v115, v14 row_newbcast:10 row_mask:0xf bank_mask:0xf
    v_add_f32_dpp v117, v117, v117 row_bcast:15 row_mask:0xa bank_mask:0xf
    v_smfmac_f32_16x16x64_bf16 v[68:71], v[76:79], v[192:199], v13
    v_and_b32_dpp v82, v114, v14 row_newbcast:11 row_mask:0xf bank_mask:0xf
    v_and_b32_dpp v83, v115, v14 row_newbcast:11 row_mask:0xf bank_mask:0xf
    v_add_f32_dpp v117, v117, v117 row_bcast:31 row_mask:0xc bank_mask:0xf
    v_smfmac_f32_16x16x64_bf16 v[72:75], v[76:79], v[200:207], v13
    v_and_b32_dpp v76, v114, v14 row_newbcast:12 row_mask:0xf bank_mask:0xf
    v_and_b32_dpp v77, v115, v14 row_newbcast:12 row_mask:0xf bank_mask:0xf
    buffer_store_dwordx2 v[116:117], v49, s[40:43], s65 offen offset:1792
    v_smfmac_f32_16x16x64_bf16 v[68:71], v[80:83], v[208:215], v13
    v_and_b32_dpp v78, v114, v14 row_newbcast:13 row_mask:0xf bank_mask:0xf
    v_and_b32_dpp v79, v115, v14 row_newbcast:13 row_mask:0xf bank_mask:0xf
    s_waitcnt lgkmcnt(0)
    v_smfmac_f32_16x16x64_bf16 v[72:75], v[80:83], v[216:223], v13
    v_and_b32_dpp v80, v114, v14 row_newbcast:14 row_mask:0xf bank_mask:0xf
    v_and_b32_dpp v81, v115, v14 row_newbcast:14 row_mask:0xf bank_mask:0xf
    v_max3_f32 v118, v100, v101, v102
    v_smfmac_f32_16x16x64_bf16 v[68:71], v[76:79], v[224:231], v13
    v_and_b32_dpp v82, v114, v14 row_newbcast:15 row_mask:0xf bank_mask:0xf
    v_and_b32_dpp v83, v115, v14 row_newbcast:15 row_mask:0xf bank_mask:0xf
    v_max_f32 v118, v118, v103
    v_smfmac_f32_16x16x64_bf16 v[72:75], v[76:79], v[232:239], v13
    v_sub_f32 v100, v100, v118
    v_sub_f32 v101, v101, v118
    v_sub_f32 v102, v102, v118
    v_smfmac_f32_16x16x64_bf16 v[68:71], v[80:83], v[240:247], v13
    v_sub_f32 v103, v103, v118
    s_cmp_ge_u32 s54, 2
    s_nop 0
    v_smfmac_f32_16x16x64_bf16 v[72:75], v[80:83], v[248:255], v13
    s_mov_b64 exec, 0xffff
    s_nop 2
    ds_write_b128 v44, v[68:71]
    s_nop 2
    ds_write_b128 v44, v[72:75] offset:16
    s_mov_b64 exec, -1
    v_exp_f32 v100, v100
    v_exp_f32 v101, v101
    v_exp_f32 v102, v102
    v_exp_f32 v103, v103
    s_waitcnt lgkmcnt(0)
    s_barrier
    s_cbranch_scc1 L_x1n
    ds_read2st64_b64 v[68:71], v47 offset0:0 offset1:1
    ds_read2st64_b64 v[72:75], v47 offset0:2 offset1:3
    buffer_load_dwordx4 v[108:111], v50, s[40:43], s65 offen offset:1792 sc1
    v_mov_b64 v[76:77], 0
    v_mov_b64 v[78:79], 0
    v_mov_b64 v[80:81], 0
    v_mov_b64 v[82:83], 0
    s_waitcnt lgkmcnt(1)
    v_pk_mul_f32 v[68:69], v[68:69], v[100:101] op_sel_hi:[1,0]
    v_pk_fma_f32 v[68:69], v[70:71], v[100:101], v[68:69] op_sel:[0,1,0]
    s_waitcnt lgkmcnt(0)
    v_pk_fma_f32 v[68:69], v[72:73], v[102:103], v[68:69] op_sel_hi:[1,0,1]
    v_pk_fma_f32 v[68:69], v[74:75], v[102:103], v[68:69] op_sel:[0,1,0]
    v_cvt_pk_bf16_f32 v68, v68, v69
    buffer_store_dword v68, v48, s[40:43], s64 offen offset:2048
    buffer_load_dwordx4 v[100:103], v9, s[40:43], s64 offen offset:2048 sc1
    buffer_load_dwordx4 v[104:107], v9, s[40:43], s64 offen offset:2112 sc1
    s_waitcnt vmcnt(3)
L_m1n:
    v_max_f32 v113, v108, v110
    v_max3_u32 v112, v108, v109, v110
    v_max_u32 v112, v112, v111
    v_max_f32_dpp v113, v113, v113 quad_perm:[1,0,3,2] row_mask:0xf bank_mask:0xf
    v_cmp_lt_u32 vcc, s60, v112
    s_cbranch_vccnz L_mr1n
    v_max_f32_dpp v114, v113, v113 quad_perm:[2,3,0,1] row_mask:0xf bank_mask:0xf
    s_nop 1
    v_max_f32_dpp v114, v114, v114 row_half_mirror row_mask:0xf bank_mask:0xf
    s_nop 1
    v_max_f32_dpp v114, v114, v114 row_mirror row_mask:0xf bank_mask:0xf
    v_sub_f32 v108, v108, v114
    v_sub_f32 v110, v110, v114
    v_exp_f32 v108, v108
    v_exp_f32 v110, v110
    v_mul_f32 v115, v108, v109
    v_fmac_f32 v115, v110, v111
    v_sub_f32 v113, v113, v114
    v_exp_f32 v113, v113
    v_add_f32_dpp v115, v115, v115 quad_perm:[1,0,3,2] row_mask:0xf bank_mask:0xf
    s_nop 1
    v_add_f32_dpp v115, v115, v115 quad_perm:[2,3,0,1] row_mask:0xf bank_mask:0xf
    s_nop 1
    v_add_f32_dpp v115, v115, v115 row_half_mirror row_mask:0xf bank_mask:0xf
    s_nop 1
    v_add_f32_dpp v115, v115, v115 row_mirror row_mask:0xf bank_mask:0xf
    v_rcp_f32 v115, v115
    s_nop 1
    v_mul_f32_dpp v114, v113, v115 row_newbcast:0 row_mask:0xf bank_mask:0xf
    v_mul_f32_dpp v113, v113, v115 row_newbcast:2 row_mask:0xf bank_mask:0xf
    v_cvt_pk_bf16_f32 v114, v114, v113
    v_cndmask_b32 v120, v114, 0, s[50:51]
    v_cndmask_b32 v121, v114, 0, s[50:51]
    v_cndmask_b32 v122, 0, v114, s[50:51]
    v_cndmask_b32 v123, 0, v114, s[50:51]
    s_branch L_o1n
L_mr1n:
    buffer_load_dwordx4 v[108:111], v50, s[40:43], s65 offen offset:1792 sc1
    buffer_load_dwordx4 v[100:103], v9, s[40:43], s64 offen offset:2048 sc1
    buffer_load_dwordx4 v[104:107], v9, s[40:43], s64 offen offset:2112 sc1
    s_add_u32 s59, s59, 0x10000
    s_cselect_b32 s60, -1, s60
    s_waitcnt vmcnt(2)
    s_branch L_m1n
L_s1n:
    s_nop 1
    v_mfma_f32_16x16x32_bf16 v[92:95], v[32:35], v[32:35], 0
    v_cvt_pk_bf16_f32 v36, v24, v25
    v_cvt_pk_bf16_f32 v37, v26, v27
    v_cvt_pk_bf16_f32 v38, v28, v29
    v_cvt_pk_bf16_f32 v39, v30, v31
    s_nop 1
    v_mfma_f32_16x16x32_bf16 v[92:95], v[36:39], v[36:39], v[92:95]
    s_nop 7
    buffer_store_dwordx2 v[92:93], v11, s[40:43], s65 offen offset:1664
    s_branch L_fin
L_or1n:
    buffer_load_dwordx4 v[100:103], v9, s[40:43], s64 offen offset:2048 sc1
    buffer_load_dwordx4 v[104:107], v9, s[40:43], s64 offen offset:2112 sc1
    s_add_u32 s59, s59, 0x10000
    s_cselect_b32 s60, -1, s60
    s_nop 2
    v_mov_b64 v[76:77], 0
    v_mov_b64 v[78:79], 0
    v_mov_b64 v[80:81], 0
    v_mov_b64 v[82:83], 0
L_o1n:
    s_waitcnt vmcnt(1)
    v_smfmac_f32_16x16x64_bf16 v[76:79], v[100:103], a[144:151], v12
    v_max3_u32 v112, v100, v101, v102
    s_waitcnt vmcnt(0)
    v_max3_u32 v112, v112, v103, v104
    v_smfmac_f32_16x16x64_bf16 v[80:83], v[100:103], a[160:167], v12
    v_max3_u32 v112, v112, v105, v106
    v_max_u32 v112, v112, v107
    v_cmp_lt_u32 vcc, s60, v112
    v_smfmac_f32_16x16x64_bf16 v[76:79], v[104:107], a[152:159], v12
    s_cbranch_vccnz L_or1n
    s_nop 1
    v_smfmac_f32_16x16x64_bf16 v[80:83], v[104:107], a[168:175], v12
    s_nop 3
    v_cvt_pk_bf16_f32 v84, v76, v77
    v_cvt_pk_bf16_f32 v85, v78, v79
    s_nop 1
    v_cvt_pk_bf16_f32 v86, v80, v81
    v_cvt_pk_bf16_f32 v87, v82, v83
    s_nop 1
    v_mfma_f32_16x16x32_bf16 v[88:91], v[120:123], v[84:87], 0
    s_nop 7
    v_cvt_pk_bf16_f32 v88, v88, v89
    buffer_store_dword v88, v51, s[40:43], s68 offen offset:0 sc1
    buffer_store_dword v88, v51, s[40:43], s49 offen offset:0 sc1
    s_mov_b64 vcc, -1
    s_waitcnt vmcnt(0)
L_g1n:
    s_mov_b64 exec, vcc
    buffer_load_dwordx4 v[100:103], v52, s[40:43], s68 offen offset:0 sc1
    buffer_load_dwordx4 v[104:107], v52, s[40:43], s68 offen offset:1024 sc1
    s_add_u32 s59, s59, 0x10000
    s_cselect_b32 s60, -1, s60
    s_waitcnt vmcnt(1)
    ds_write2_b64 v54, v[100:101], v[102:103] offset0:0 offset1:128
    v_max3_u32 v112, v100, v101, v102
    s_waitcnt vmcnt(0)
    ds_write2_b64 v54, v[104:105], v[106:107] offset0:32 offset1:160
    v_max3_u32 v112, v112, v103, v104
    v_max3_u32 v112, v112, v105, v106
    v_max_u32 v112, v112, v107
    v_cmp_lt_u32 vcc, s60, v112
    s_cbranch_vccnz L_g1n
    s_mov_b64 exec, -1
    s_waitcnt lgkmcnt(0)
L_x1n:
    s_cmp_eq_u32 s54, 3
    s_barrier
    ds_read_b64_tr_b16 v[68:69], v53 offset:0
    ds_read_b64_tr_b16 v[70:71], v53 offset:512
    ds_read_b64_tr_b16 v[72:73], v53 offset:1024
    ds_read_b64_tr_b16 v[74:75], v53 offset:1536
    ds_read_b64_tr_b16 v[76:77], v53 offset:2176
    ds_read_b64_tr_b16 v[78:79], v53 offset:2688
    ds_read_b64_tr_b16 v[80:81], v53 offset:3200
    ds_read_b64_tr_b16 v[82:83], v53 offset:3712
    s_waitcnt lgkmcnt(6)
    v_mfma_f32_16x16x32_bf16 v[16:19], v[68:71], a[208:211], v[16:19]
    s_waitcnt lgkmcnt(4)
    s_nop 1
    v_mfma_f32_16x16x32_bf16 v[20:23], v[72:75], a[208:211], v[20:23]
    s_waitcnt lgkmcnt(2)
    s_nop 1
    v_mfma_f32_16x16x32_bf16 v[24:27], v[76:79], a[208:211], v[24:27]
    v_cvt_pk_bf16_f32 v32, v16, v17
    v_cvt_pk_bf16_f32 v33, v18, v19
    s_waitcnt lgkmcnt(0)
    v_mfma_f32_16x16x32_bf16 v[28:31], v[80:83], a[208:211], v[28:31]
    v_cvt_pk_bf16_f32 v34, v20, v21
    v_cvt_pk_bf16_f32 v35, v22, v23
    s_cbranch_scc1 L_s1n
    s_nop 0
    v_mfma_f32_16x16x32_bf16 v[84:87], v[32:35], a[176:179], 0
    v_cvt_pk_bf16_f32 v36, v24, v25
    v_cvt_pk_bf16_f32 v37, v26, v27
    s_nop 0
    v_mfma_f32_16x16x32_bf16 v[88:91], v[32:35], a[184:187], 0
    v_cvt_pk_bf16_f32 v38, v28, v29
    v_cvt_pk_bf16_f32 v39, v30, v31
    s_nop 0
    s_nop 0
    v_mfma_f32_16x16x32_bf16 v[84:87], v[36:39], a[180:183], v[84:87]
    s_nop 2
    v_mfma_f32_16x16x32_bf16 v[88:91], v[36:39], a[188:191], v[88:91]
    s_cmp_eq_u32 s54, 2
    s_nop 6
    v_cvt_pk_bf16_f32 v112, v84, v88
    buffer_store_dword v112, v55, s[40:43], s65 offen offset:0
    s_cbranch_scc1 L_fin
    v_mov_b64 v[68:69], 0
    v_mov_b64 v[70:71], 0
    v_mov_b64 v[72:73], 0
    v_mov_b64 v[74:75], 0
L_c1n:
    buffer_load_dwordx4 v[108:111], v10, s[40:43], s65 offen offset:1664 sc1
    buffer_load_dwordx4 v[100:103], v56, s[40:43], s65 offen offset:0 sc1
    buffer_load_dwordx4 v[104:107], v56, s[40:43], s65 offen offset:16 sc1
    s_add_u32 s59, s59, 0x10000
    s_cselect_b32 s60, -1, s60
    s_waitcnt vmcnt(2)
    v_pk_add_f32 v[114:115], v[108:109], v[110:111]
    v_max3_u32 v112, v108, v109, v110
    s_waitcnt vmcnt(1)
    v_mfma_f32_16x16x32_bf16 v[76:79], a[212:215], v[100:103], 0
    v_add_f32_dpp v115, v115, v115 quad_perm:[1,0,3,2] row_mask:0xf bank_mask:0xf
    v_add_f32_dpp v114, v114, v114 quad_perm:[1,0,3,2] row_mask:0xf bank_mask:0xf
    v_max3_u32 v112, v112, v111, v100
    s_waitcnt vmcnt(0)
    v_mfma_f32_16x16x32_bf16 v[76:79], a[212:215], v[104:107], v[76:79]
    v_max3_u32 v112, v112, v101, v102
    v_max3_u32 v112, v112, v103, v104
    v_max3_u32 v112, v112, v105, v106
    v_max_u32 v112, v112, v107
    v_cmp_lt_u32 vcc, s60, v112
    v_add_f32_dpp v109, v115, v115 quad_perm:[2,3,0,1] row_mask:0xf bank_mask:0xf
    s_cbranch_vccnz L_c1n
    v_add_f32_dpp v108, v114, v114 quad_perm:[2,3,0,1] row_mask:0xf bank_mask:0xf
    v_mul_f32 v110, 0xbb000000, v109
    v_fmamk_f32 v108, v108, 0x3b000000, v15
    v_fma_f32 v108, -v110, v110, v108
    v_max_f32 v108, v108, v15
    v_rsq_f32 v112, v108
    v_pk_fma_f32 v[76:77], v[42:43], v[110:111], v[76:77] op_sel_hi:[1,0,1]
    v_mul_f32 v112, 0xbfb8aa3b, v112
    v_mul_f32 v112, v76, v112
    v_exp_f32 v112, v112
    v_mul_f32 v76, v76, v77
    v_fmac_f32 v108, v112, v108
    v_rcp_f32 v108, v108
    s_nop 0
    v_mul_f32 v76, v76, v108
    v_cvt_pk_bf16_f32 v76, v76, v76
    v_and_b32 v100, v76, v57
    v_and_b32 v101, v76, v58
    v_and_b32 v102, v76, v59
    v_and_b32 v103, v76, v60
    s_nop 1
    v_smfmac_f32_16x16x64_bf16 v[68:71], v[100:103], a[192:199], v13
    s_nop 2
    v_smfmac_f32_16x16x64_bf16 v[72:75], v[100:103], a[200:207], v13
    s_nop 3
    v_cvt_pk_bf16_f32 v84, v68, v69
    v_cvt_pk_bf16_f32 v85, v70, v71
    s_nop 1
    v_cvt_pk_bf16_f32 v86, v72, v73
    v_cvt_pk_bf16_f32 v87, v74, v75
    s_nop 1
    v_mfma_f32_16x16x32_bf16 v[88:91], a[216:219], v[84:87], 0
    s_cmp_lg_u32 s52, 0
    s_mov_b64 exec, 0xffff
    s_nop 5
    v_cvt_pk_bf16_f32 v88, v88, v89
    buffer_store_dword v88, v51, s[40:43], s69 offen offset:0 sc1
    s_mov_b64 exec, -1
    s_cbranch_scc1 L_fin
    s_lshl4_add_u32 s56, s53, s54
    s_lshl_b32 s56, s56, 3
    v_lshl_add_u32 v64, v3, 5, s56
    v_lshl_add_u32 v64, v2, 10, v64
    s_cmp_eq_u32 s54, 0
    s_cbranch_scc1 L_z1n
    v_add_u32 v53, 2176, v53
    v_mov_b64 v[16:17], v[24:25]
    v_mov_b64 v[18:19], v[26:27]
    v_mov_b64 v[20:21], v[28:29]
    v_mov_b64 v[22:23], v[30:31]
L_z1n:
    s_mov_b64 vcc, -1
    s_waitcnt vmcnt(0)
L_h1n:
    s_mov_b64 exec, vcc
    buffer_load_dwordx4 v[100:103], v52, s[40:43], s69 offen offset:0 sc1
    buffer_load_dwordx4 v[104:107], v52, s[40:43], s69 offen offset:1024 sc1
    s_add_u32 s59, s59, 0x10000
    s_cselect_b32 s60, -1, s60
    s_waitcnt vmcnt(1)
    ds_write2_b64 v54, v[100:101], v[102:103] offset0:0 offset1:128
    v_max3_u32 v112, v100, v101, v102
    s_waitcnt vmcnt(0)
    ds_write2_b64 v54, v[104:105], v[106:107] offset0:32 offset1:160
    v_max3_u32 v112, v112, v103, v104
    v_max3_u32 v112, v112, v105, v106
    v_max_u32 v112, v112, v107
    v_cmp_lt_u32 vcc, s60, v112
    s_cbranch_vccnz L_h1n
    s_mov_b64 exec, -1
    s_waitcnt lgkmcnt(0)
    s_barrier
    ds_read_b64_tr_b16 v[68:69], v53 offset:0
    ds_read_b64_tr_b16 v[70:71], v53 offset:512
    ds_read_b64_tr_b16 v[72:73], v53 offset:1024
    ds_read_b64_tr_b16 v[74:75], v53 offset:1536
    s_waitcnt lgkmcnt(2)
    v_mfma_f32_16x16x32_bf16 v[16:19], v[68:71], a[208:211], v[16:19]
    s_waitcnt lgkmcnt(0)
    s_nop 1
    v_mfma_f32_16x16x32_bf16 v[20:23], v[72:75], a[208:211], v[20:23]
    s_nop 3
    v_cvt_pk_bf16_f32 v32, v16, v18
    v_cvt_pk_bf16_f32 v34, v17, v19
    s_nop 1
    v_cvt_pk_bf16_f32 v33, v20, v22
    buffer_store_dwordx2 v[32:33], v64, s[32:35], 0 offen
    v_cvt_pk_bf16_f32 v35, v21, v23
    buffer_store_dwordx2 v[34:35], v64, s[32:35], 0 offen offset:16
L_fin:
L_end:
    s_endpgm
L_chk_retry:
    buffer_load_dword v114, v115, s[36:39], 0 offen sc1
    s_andn2_b32 s56, 0x30000, s59
    s_cbranch_scc1 L_chk_wait
    s_lshl_b32 s56, s53, 3
    s_lshl_b32 s56, 0xff, s56
    s_and_b32 s56, s56, s61
    s_lshr_b32 s57, s53, 2
    v_mov_b32 v120, s56
    v_cmp_eq_u32 vcc, s57, v0
    s_nop 1
    v_cndmask_b32 v120, 0, v120, vcc
    buffer_atomic_or v120, v115, s[36:39], 0 offen sc0 sc1
    s_waitcnt vmcnt(0)
    v_or_b32 v114, v114, v120
L_chk_wait:
    s_add_u32 s59, s59, 0x10000
    s_cselect_b32 s60, -1, s60
    s_waitcnt vmcnt(0)
    s_cbranch_scc0 L_chk
L_chk_far:
    s_lshl_b32 s56, s53, 3
    s_lshl_b32 s56, 0xff, s56
    s_and_b32 s56, s56, s61
    s_lshr_b32 s57, s53, 2
    v_mov_b32 v120, s56
    v_cmp_eq_u32 vcc, s57, v0
    s_nop 1
    v_cndmask_b32 v120, 0, v120, vcc
    buffer_atomic_or v120, v115, s[36:39], 0 offen sc1
    s_waitcnt vmcnt(0)
    s_branch L_chk_ok
L_team:
    v_or_b32 v220, 64, v220
    buffer_store_byte v220, v219, s[36:39], 0 offen sc1
    s_branch L_team_done
L_q0_far:
    buffer_store_dwordx2 v[116:117], v221, s[40:43], s62 offen offset:0 sc1
    s_waitcnt vmcnt(0)
    s_branch L_q0
L_q0_retry:
    buffer_load_dwordx4 v[100:103], v9, s[40:43], s62 offen offset:0 sc1
    buffer_load_dwordx4 v[104:107], v9, s[40:43], s62 offen offset:64 sc1
    buffer_load_dwordx4 v[120:123], v9, s[40:43], s63 offen offset:2048 sc1
    buffer_load_dwordx4 v[124:127], v9, s[40:43], s63 offen offset:2112 sc1
    s_add_u32 s59, s59, 0x10000
    s_cselect_b32 s60, -1, s60
    s_waitcnt vmcnt(0)
    s_branch L_q0
L_ml_far:
    buffer_store_dwordx2 v[116:117], v49, s[40:43], s63 offen offset:1792 sc1
    s_branch L_ml
L_all_retry:
    s_andn2_b32 s56, 0x30000, s59
    s_cbranch_scc1 L_all_load
    v_mov_b32 v120, 0
    buffer_atomic_or v120, v119, s[36:39], 0 offen sc0 sc1
    s_branch L_all_wait
L_all_load:
    buffer_load_dword v120, v119, s[36:39], 0 offen sc1
L_all_wait:
    s_add_u32 s59, s59, 0x10000
    s_cselect_b32 s60, -1, s60
    s_waitcnt vmcnt(0)
    s_cbranch_scc0 L_all
    s_branch L_all_ok
L_w0n:
    s_waitcnt vmcnt(0)
    s_barrier
    v_lshrrev_b32 v124, 2, v1
    v_mul_u32_u24 v124, 96, v124
    v_and_b32 v125, 3, v0
    v_lshlrev_b32 v125, 3, v125
    s_lshl_b32 s56, s54, 5
    s_add_u32 s56, s56, 66560
    v_add3_u32 v64, v124, v125, s56
    s_cmp_eq_u32 s54, 3
    s_cselect_b32 s55, 36352, 0
    s_cselect_b32 s57, 3072, 0
    s_barrier
    s_add_u32 m0, s55, 66560
    s_mov_b32 s58, 0
    buffer_load_dwordx4 v61, s[24:27], s58 offen nt lds
    s_add_u32 m0, s55, 67584
    s_mov_b32 s58, 0
    buffer_load_dwordx4 v62, s[24:27], s58 offen nt lds
    s_add_u32 m0, s55, 68608
    s_mov_b32 s58, 0
    buffer_load_dwordx4 v63, s[24:27], s58 offen nt lds
    s_add_u32 m0, s55, 69632
    s_mov_b32 s58, 11008
    buffer_load_dwordx4 v61, s[24:27], s58 offen nt lds
    s_add_u32 m0, s55, 70656
    s_mov_b32 s58, 11008
    buffer_load_dwordx4 v62, s[24:27], s58 offen nt lds
    s_add_u32 m0, s55, 71680
    s_mov_b32 s58, 11008
    buffer_load_dwordx4 v63, s[24:27], s58 offen nt lds
    s_add_u32 m0, s57, 96768
    s_mov_b32 s58, 0
    buffer_load_dwordx4 v7, s[28:31], s58 offen nt lds
    s_add_u32 m0, s57, 97792
    s_mov_b32 s58, 8192
    buffer_load_dwordx4 v7, s[28:31], s58 offen nt lds
    s_add_u32 m0, s57, 98816
    s_mov_b32 s58, 16384
    buffer_load_dwordx4 v7, s[28:31], s58 offen nt lds
    s_waitcnt vmcnt(0)
    s_branch L_x0n
L_sr1n:
    buffer_load_dwordx4 v[108:111], v10, s[40:43], s65 offen offset:1536 sc1
    s_add_u32 s59, s59, 0x10000
    s_cselect_b32 s60, -1, s60
    s_waitcnt vmcnt(0)
    v_max3_u32 v112, v108, v109, v110
    v_max_u32 v112, v112, v111
    v_cmp_lt_u32 vcc, s60, v112
    s_cbranch_vccnz L_sr1n
    s_branch L_sb1n
L_far:
    s_nop 1
    s_waitcnt vmcnt(8)
    v_swap_b32 v226, v232
    v_swap_b32 v227, v233
    v_swap_b32 v230, v236
    v_swap_b32 v231, v237
    s_nop 1
    v_smfmac_f32_16x16x64_bf16 v[68:71], v[76:79], v[224:231], v13
    v_and_b32_dpp v80, v114, v14 row_newbcast:14 row_mask:0xf bank_mask:0xf
    v_and_b32_dpp v81, v115, v14 row_newbcast:14 row_mask:0xf bank_mask:0xf
    s_nop 0
    v_smfmac_f32_16x16x64_bf16 v[72:75], v[76:79], v[232:239], v13
    v_and_b32_dpp v82, v114, v14 row_newbcast:15 row_mask:0xf bank_mask:0xf
    v_and_b32_dpp v83, v115, v14 row_newbcast:15 row_mask:0xf bank_mask:0xf
    s_waitcnt vmcnt(4)
    v_swap_b32 v242, v248
    v_swap_b32 v243, v249
    v_swap_b32 v246, v252
    v_swap_b32 v247, v253
    s_nop 1
    v_smfmac_f32_16x16x64_bf16 v[68:71], v[80:83], v[240:247], v13
    s_cmp_ge_u32 s54, 2
    s_nop 1
    v_smfmac_f32_16x16x64_bf16 v[72:75], v[80:83], v[248:255], v13
    s_mov_b64 exec, 0xffff
    s_nop 2
    ds_write_b128 v44, v[68:71]
    s_nop 2
    ds_write_b128 v44, v[72:75] offset:16
    s_mov_b64 exec, -1
    s_waitcnt lgkmcnt(0)
    s_barrier
    s_cbranch_scc1 L_w0f
    ds_read2st64_b64 v[68:71], v47 offset0:0 offset1:1
    ds_read2st64_b64 v[72:75], v47 offset0:2 offset1:3
    buffer_load_dwordx4 v[108:111], v50, s[40:43], s63 offen offset:1792 sc1
    v_mov_b64 v[76:77], 0
    v_mov_b64 v[78:79], 0
    v_mov_b64 v[80:81], 0
    v_mov_b64 v[82:83], 0
    s_waitcnt lgkmcnt(1)
    v_pk_mul_f32 v[68:69], v[68:69], v[100:101] op_sel_hi:[1,0]
    v_pk_fma_f32 v[68:69], v[70:71], v[100:101], v[68:69] op_sel:[0,1,0]
    s_waitcnt lgkmcnt(0)
    v_pk_fma_f32 v[68:69], v[72:73], v[102:103], v[68:69] op_sel_hi:[1,0,1]
    v_pk_fma_f32 v[68:69], v[74:75], v[102:103], v[68:69] op_sel:[0,1,0]
    v_cvt_pk_bf16_f32 v68, v68, v69
    buffer_store_dword v68, v48, s[40:43], s62 offen offset:2048 sc1
    buffer_load_dwordx4 v[100:103], v9, s[40:43], s62 offen offset:2048 sc1
    buffer_load_dwordx4 v[104:107], v9, s[40:43], s62 offen offset:2112 sc1
    s_waitcnt vmcnt(3)
    s_barrier
    ds_read_b64_tr_b16 a[144:145], v64 offset:0
    ds_read_b64_tr_b16 a[146:147], v64 offset:512
    ds_read_b64_tr_b16 a[148:149], v64 offset:33280
    ds_read_b64_tr_b16 a[150:151], v64 offset:33792
    ds_read_b64_tr_b16 a[160:161], v64 offset:16
    ds_read_b64_tr_b16 a[162:163], v64 offset:528
    ds_read_b64_tr_b16 a[164:165], v64 offset:33296
    ds_read_b64_tr_b16 a[166:167], v64 offset:33808
    s_waitcnt lgkmcnt(6)
    ds_read_b64_tr_b16 a[152:153], v65 offset:0
    ds_read_b64_tr_b16 a[154:155], v65 offset:512
    ds_read_b64_tr_b16 a[156:157], v65 offset:33280
    ds_read_b64_tr_b16 a[158:159], v65 offset:33792
    ds_read_b64_tr_b16 a[168:169], v65 offset:16
    ds_read_b64_tr_b16 a[170:171], v65 offset:528
    ds_read_b64_tr_b16 a[172:173], v65 offset:33296
    ds_read_b64_tr_b16 a[174:175], v65 offset:33808
L_m0f:
    v_max_f32 v113, v108, v110
    v_max3_u32 v112, v108, v109, v110
    v_max_u32 v112, v112, v111
    v_max_f32_dpp v113, v113, v113 quad_perm:[1,0,3,2] row_mask:0xf bank_mask:0xf
    v_cmp_lt_u32 vcc, s60, v112
    s_cbranch_vccnz L_mr0f
    v_max_f32_dpp v114, v113, v113 quad_perm:[2,3,0,1] row_mask:0xf bank_mask:0xf
    s_nop 1
    v_max_f32_dpp v114, v114, v114 row_half_mirror row_mask:0xf bank_mask:0xf
    s_nop 1
    v_max_f32_dpp v114, v114, v114 row_mirror row_mask:0xf bank_mask:0xf
    v_sub_f32 v108, v108, v114
    v_sub_f32 v110, v110, v114
    v_exp_f32 v108, v108
    v_exp_f32 v110, v110
    v_mul_f32 v115, v108, v109
    v_fmac_f32 v115, v110, v111
    v_sub_f32 v113, v113, v114
    v_exp_f32 v113, v113
    v_add_f32_dpp v115, v115, v115 quad_perm:[1,0,3,2] row_mask:0xf bank_mask:0xf
    s_nop 1
    v_add_f32_dpp v115, v115, v115 quad_perm:[2,3,0,1] row_mask:0xf bank_mask:0xf
    s_nop 1
    v_add_f32_dpp v115, v115, v115 row_half_mirror row_mask:0xf bank_mask:0xf
    s_nop 1
    v_add_f32_dpp v115, v115, v115 row_mirror row_mask:0xf bank_mask:0xf
    v_rcp_f32 v115, v115
    s_nop 1
    v_mul_f32_dpp v114, v113, v115 row_newbcast:0 row_mask:0xf bank_mask:0xf
    v_mul_f32_dpp v113, v113, v115 row_newbcast:2 row_mask:0xf bank_mask:0xf
    v_cvt_pk_bf16_f32 v114, v114, v113
    v_cndmask_b32 v120, v114, 0, s[50:51]
    v_cndmask_b32 v121, v114, 0, s[50:51]
    v_cndmask_b32 v122, 0, v114, s[50:51]
    v_cndmask_b32 v123, 0, v114, s[50:51]
    s_branch L_o0f
L_mr0f:
    buffer_load_dwordx4 v[108:111], v50, s[40:43], s63 offen offset:1792 sc1
    buffer_load_dwordx4 v[100:103], v9, s[40:43], s62 offen offset:2048 sc1
    buffer_load_dwordx4 v[104:107], v9, s[40:43], s62 offen offset:2112 sc1
    s_add_u32 s59, s59, 0x10000
    s_cselect_b32 s60, -1, s60
    s_waitcnt vmcnt(2)
    s_branch L_m0f
L_s0f:
    s_nop 1
    v_mfma_f32_16x16x32_bf16 v[92:95], v[32:35], v[32:35], 0
    v_cvt_pk_bf16_f32 v36, v24, v25
    v_cvt_pk_bf16_f32 v37, v26, v27
    v_cvt_pk_bf16_f32 v38, v28, v29
    v_cvt_pk_bf16_f32 v39, v30, v31
    s_nop 1
    v_mfma_f32_16x16x32_bf16 v[92:95], v[36:39], v[36:39], v[92:95]
    s_nop 7
    buffer_store_dwordx2 v[92:93], v11, s[40:43], s63 offen offset:1664 sc1
    s_branch L_y0f
L_or0f:
    buffer_load_dwordx4 v[100:103], v9, s[40:43], s62 offen offset:2048 sc1
    buffer_load_dwordx4 v[104:107], v9, s[40:43], s62 offen offset:2112 sc1
    s_add_u32 s59, s59, 0x10000
    s_cselect_b32 s60, -1, s60
    s_nop 2
    v_mov_b64 v[76:77], 0
    v_mov_b64 v[78:79], 0
    v_mov_b64 v[80:81], 0
    v_mov_b64 v[82:83], 0
L_o0f:
    s_waitcnt vmcnt(1)
    s_waitcnt lgkmcnt(0)
    v_smfmac_f32_16x16x64_bf16 v[76:79], v[100:103], a[144:151], v12
    v_max3_u32 v112, v100, v101, v102
    s_waitcnt vmcnt(0)
    v_max3_u32 v112, v112, v103, v104
    v_smfmac_f32_16x16x64_bf16 v[80:83], v[100:103], a[160:167], v12
    v_max3_u32 v112, v112, v105, v106
    v_max_u32 v112, v112, v107
    v_cmp_lt_u32 vcc, s60, v112
    v_smfmac_f32_16x16x64_bf16 v[76:79], v[104:107], a[152:159], v12
    s_cbranch_vccnz L_or0f
    s_nop 1
    v_smfmac_f32_16x16x64_bf16 v[80:83], v[104:107], a[168:175], v12
    s_barrier
    s_nop 2
    v_cvt_pk_bf16_f32 v84, v76, v77
    v_cvt_pk_bf16_f32 v85, v78, v79
    s_nop 1
    v_cvt_pk_bf16_f32 v86, v80, v81
    v_cvt_pk_bf16_f32 v87, v82, v83
    s_nop 1
    v_mfma_f32_16x16x32_bf16 v[88:91], v[120:123], v[84:87], 0
    s_nop 7
    v_cvt_pk_bf16_f32 v88, v88, v89
    buffer_store_dword v88, v51, s[40:43], s66 offen offset:0 sc1
    buffer_store_dword v88, v51, s[40:43], s47 offen offset:0 sc1
    v_lshlrev_b32 v124, 6, v3
    v_sub_u32 v124, v64, v124
    v_add_u32 v65, 80384, v124
    v_lshrrev_b32 v124, 2, v1
    v_mul_u32_u24 v124, 96, v124
    v_and_b32 v125, 3, v0
    v_lshlrev_b32 v125, 3, v125
    s_lshl_b32 s56, s54, 5
    s_add_u32 s56, s56, 66560
    v_add3_u32 v64, v124, v125, s56
    s_mov_b64 vcc, -1
    s_waitcnt vmcnt(0)
L_g0f:
    s_mov_b64 exec, vcc
    buffer_load_dwordx4 v[100:103], v52, s[40:43], s66 offen offset:0 sc1
    buffer_load_dwordx4 v[104:107], v52, s[40:43], s66 offen offset:1024 sc1
    s_add_u32 s59, s59, 0x10000
    s_cselect_b32 s60, -1, s60
    s_waitcnt vmcnt(1)
    ds_write2_b64 v54, v[100:101], v[102:103] offset0:0 offset1:128
    v_max3_u32 v112, v100, v101, v102
    s_waitcnt vmcnt(0)
    ds_write2_b64 v54, v[104:105], v[106:107] offset0:32 offset1:160
    v_max3_u32 v112, v112, v103, v104
    v_max3_u32 v112, v112, v105, v106
    v_max_u32 v112, v112, v107
    v_cmp_lt_u32 vcc, s60, v112
    s_cbranch_vccnz L_g0f
    s_mov_b64 exec, -1
    s_waitcnt lgkmcnt(0)
L_x0f:
    s_cmp_eq_u32 s54, 3
    s_barrier
    ds_read_b64_tr_b16 v[68:69], v53 offset:0
    ds_read_b64_tr_b16 v[70:71], v53 offset:512
    ds_read_b64_tr_b16 v[72:73], v53 offset:1024
    ds_read_b64_tr_b16 v[74:75], v53 offset:1536
    ds_read_b64_tr_b16 v[76:77], v53 offset:2176
    ds_read_b64_tr_b16 v[78:79], v53 offset:2688
    ds_read_b64_tr_b16 v[80:81], v53 offset:3200
    ds_read_b64_tr_b16 v[82:83], v53 offset:3712
    ds_read_b64_tr_b16 a[176:177], v64 offset:0
    ds_read_b64_tr_b16 a[178:179], v64 offset:1536
    ds_read_b64_tr_b16 a[184:185], v64 offset:36352
    ds_read_b64_tr_b16 a[186:187], v64 offset:37888
    s_waitcnt lgkmcnt(10)
    v_mfma_f32_16x16x32_bf16 v[16:19], v[68:71], a[208:211], v[16:19]
    ds_read_b64_tr_b16 a[180:181], v64 offset:3072
    ds_read_b64_tr_b16 a[182:183], v64 offset:4608
    s_waitcnt lgkmcnt(10)
    v_mfma_f32_16x16x32_bf16 v[20:23], v[72:75], a[208:211], v[20:23]
    ds_read_b64_tr_b16 a[188:189], v64 offset:39424
    ds_read_b64_tr_b16 a[190:191], v64 offset:40960
    s_waitcnt lgkmcnt(10)
    v_mfma_f32_16x16x32_bf16 v[24:27], v[76:79], a[208:211], v[24:27]
    v_cvt_pk_bf16_f32 v32, v16, v17
    v_cvt_pk_bf16_f32 v33, v18, v19
    s_waitcnt lgkmcnt(8)
    v_mfma_f32_16x16x32_bf16 v[28:31], v[80:83], a[208:211], v[28:31]
    v_cvt_pk_bf16_f32 v34, v20, v21
    v_cvt_pk_bf16_f32 v35, v22, v23
    s_cbranch_scc1 L_s0f
    s_waitcnt lgkmcnt(4)
    v_mfma_f32_16x16x32_bf16 v[84:87], v[32:35], a[176:179], 0
    v_cvt_pk_bf16_f32 v36, v24, v25
    v_cvt_pk_bf16_f32 v37, v26, v27
    s_nop 0
    v_mfma_f32_16x16x32_bf16 v[88:91], v[32:35], a[184:187], 0
    v_cvt_pk_bf16_f32 v38, v28, v29
    v_cvt_pk_bf16_f32 v39, v30, v31
    s_waitcnt lgkmcnt(0)
    s_nop 0
    v_mfma_f32_16x16x32_bf16 v[84:87], v[36:39], a[180:183], v[84:87]
    s_nop 2
    v_mfma_f32_16x16x32_bf16 v[88:91], v[36:39], a[188:191], v[88:91]
    s_cmp_eq_u32 s54, 2
    s_nop 6
    v_cvt_pk_bf16_f32 v112, v84, v88
    buffer_store_dword v112, v55, s[40:43], s63 offen offset:0 sc1
    v_cvt_pk_bf16_f32 v113, v85, v89
    buffer_store_dword v113, v55, s[40:43], s65 offen offset:2048 sc1
    s_cbranch_scc1 L_y0f
    ds_read_b64_tr_b16 a[192:193], v65 offset:0
    ds_read_b64_tr_b16 a[194:195], v65 offset:512
    ds_read_b64_tr_b16 a[196:197], v65 offset:4096
    ds_read_b64_tr_b16 a[198:199], v65 offset:4608
    ds_read_b64_tr_b16 a[200:201], v65 offset:16
    ds_read_b64_tr_b16 a[202:203], v65 offset:528
    ds_read_b64_tr_b16 a[204:205], v65 offset:4112
    ds_read_b64_tr_b16 a[206:207], v65 offset:4624
    v_mov_b64 v[68:69], 0
    v_mov_b64 v[70:71], 0
    v_mov_b64 v[72:73], 0
    v_mov_b64 v[74:75], 0
L_c0f:
    buffer_load_dwordx4 v[108:111], v10, s[40:43], s63 offen offset:1664 sc1
    buffer_load_dwordx4 v[100:103], v56, s[40:43], s63 offen offset:0 sc1
    buffer_load_dwordx4 v[104:107], v56, s[40:43], s63 offen offset:16 sc1
    buffer_load_dwordx4 v[120:123], v56, s[40:43], s65 offen offset:2048 sc1
    buffer_load_dwordx4 v[124:127], v56, s[40:43], s65 offen offset:2064 sc1
    s_add_u32 s59, s59, 0x10000
    s_cselect_b32 s60, -1, s60
    s_waitcnt vmcnt(4)
    v_pk_add_f32 v[114:115], v[108:109], v[110:111]
    v_max3_u32 v112, v108, v109, v110
    s_waitcnt vmcnt(3)
    v_mfma_f32_16x16x32_bf16 v[76:79], a[212:215], v[100:103], 0
    v_add_f32_dpp v115, v115, v115 quad_perm:[1,0,3,2] row_mask:0xf bank_mask:0xf
    v_add_f32_dpp v114, v114, v114 quad_perm:[1,0,3,2] row_mask:0xf bank_mask:0xf
    v_max3_u32 v112, v112, v111, v100
    s_waitcnt vmcnt(2)
    v_mfma_f32_16x16x32_bf16 v[76:79], a[212:215], v[104:107], v[76:79]
    v_max3_u32 v112, v112, v101, v102
    v_max3_u32 v112, v112, v103, v104
    v_max3_u32 v112, v112, v105, v106
    s_waitcnt vmcnt(1)
    v_mfma_f32_16x16x32_bf16 v[80:83], a[212:215], v[120:123], 0
    v_max3_u32 v112, v112, v107, v120
    v_max3_u32 v112, v112, v121, v122
    s_waitcnt vmcnt(0)
    v_mfma_f32_16x16x32_bf16 v[80:83], a[212:215], v[124:127], v[80:83]
    v_max3_u32 v112, v112, v123, v124
    v_max3_u32 v112, v112, v125, v126
    v_max_u32 v112, v112, v127
    v_cmp_lt_u32 vcc, s60, v112
    v_add_f32_dpp v109, v115, v115 quad_perm:[2,3,0,1] row_mask:0xf bank_mask:0xf
    s_cbranch_vccnz L_c0f
    v_add_f32_dpp v108, v114, v114 quad_perm:[2,3,0,1] row_mask:0xf bank_mask:0xf
    v_mul_f32 v110, 0xbb000000, v109
    v_fmamk_f32 v108, v108, 0x3b000000, v15
    v_fma_f32 v108, -v110, v110, v108
    v_max_f32 v108, v108, v15
    v_rsq_f32 v112, v108
    v_pk_fma_f32 v[76:77], v[80:81], v[110:111], v[76:77] op_sel_hi:[1,0,1]
    v_mul_f32 v112, 0xbfb8aa3b, v112
    v_mul_f32 v112, v76, v112
    v_exp_f32 v112, v112
    v_mul_f32 v76, v76, v77
    v_fmac_f32 v108, v112, v108
    v_rcp_f32 v108, v108
    v_mov_b64 v[42:43], v[80:81]
    v_mul_f32 v76, v76, v108
    v_cvt_pk_bf16_f32 v76, v76, v76
    v_and_b32 v100, v76, v57
    v_and_b32 v101, v76, v58
    v_and_b32 v102, v76, v59
    v_and_b32 v103, v76, v60
    s_waitcnt lgkmcnt(0)
    s_nop 0
    v_smfmac_f32_16x16x64_bf16 v[68:71], v[100:103], a[192:199], v13
    s_nop 2
    v_smfmac_f32_16x16x64_bf16 v[72:75], v[100:103], a[200:207], v13
    s_nop 3
    v_cvt_pk_bf16_f32 v84, v68, v69
    v_cvt_pk_bf16_f32 v85, v70, v71
    s_nop 1
    v_cvt_pk_bf16_f32 v86, v72, v73
    v_cvt_pk_bf16_f32 v87, v74, v75
    s_nop 1
    v_mfma_f32_16x16x32_bf16 v[88:91], a[216:219], v[84:87], 0
    s_nop 7
    v_cvt_pk_bf16_f32 v88, v88, v89
    buffer_store_dword v88, v51, s[40:43], s67 offen offset:0 sc1
    buffer_store_dword v88, v51, s[40:43], s48 offen offset:0 sc1
    s_mov_b64 vcc, -1
    s_waitcnt vmcnt(0)
L_h0f:
    s_mov_b64 exec, vcc
    buffer_load_dwordx4 v[100:103], v52, s[40:43], s67 offen offset:0 sc1
    buffer_load_dwordx4 v[104:107], v52, s[40:43], s67 offen offset:1024 sc1
    s_add_u32 s59, s59, 0x10000
    s_cselect_b32 s60, -1, s60
    s_waitcnt vmcnt(1)
    ds_write2_b64 v54, v[100:101], v[102:103] offset0:0 offset1:128
    v_max3_u32 v112, v100, v101, v102
    s_waitcnt vmcnt(0)
    ds_write2_b64 v54, v[104:105], v[106:107] offset0:32 offset1:160
    v_max3_u32 v112, v112, v103, v104
    v_max3_u32 v112, v112, v105, v106
    v_max_u32 v112, v112, v107
    v_cmp_lt_u32 vcc, s60, v112
    s_cbranch_vccnz L_h0f
    s_mov_b64 exec, -1
    s_waitcnt lgkmcnt(0)
L_y0f:
    s_barrier
    ds_read_b64_tr_b16 v[68:69], v53 offset:0
    ds_read_b64_tr_b16 v[70:71], v53 offset:512
    ds_read_b64_tr_b16 v[72:73], v53 offset:1024
    ds_read_b64_tr_b16 v[74:75], v53 offset:1536
    ds_read_b64_tr_b16 v[76:77], v53 offset:2176
    ds_read_b64_tr_b16 v[78:79], v53 offset:2688
    ds_read_b64_tr_b16 v[80:81], v53 offset:3200
    ds_read_b64_tr_b16 v[82:83], v53 offset:3712
    s_waitcnt lgkmcnt(6)
    v_mfma_f32_16x16x32_bf16 v[16:19], v[68:71], a[208:211], v[16:19]
    s_waitcnt lgkmcnt(4)
    s_nop 1
    v_mfma_f32_16x16x32_bf16 v[20:23], v[72:75], a[208:211], v[20:23]
    s_waitcnt lgkmcnt(2)
    s_nop 1
    v_mfma_f32_16x16x32_bf16 v[24:27], v[76:79], a[208:211], v[24:27]
    v_cvt_pk_bf16_f32 v32, v16, v17
    v_cvt_pk_bf16_f32 v33, v18, v19
    s_waitcnt lgkmcnt(0)
    v_mfma_f32_16x16x32_bf16 v[28:31], v[80:83], a[208:211], v[28:31]
    v_cvt_pk_bf16_f32 v34, v20, v21
    v_cvt_pk_bf16_f32 v35, v22, v23
    s_nop 0
    s_nop 0
    v_mfma_f32_16x16x32_bf16 v[84:87], a[128:131], v[32:35], 0
    v_cvt_pk_bf16_f32 v36, v24, v25
    v_cvt_pk_bf16_f32 v37, v26, v27
    s_nop 0
    v_mfma_f32_16x16x32_bf16 v[88:91], a[136:139], v[32:35], 0
    v_cvt_pk_bf16_f32 v38, v28, v29
    v_cvt_pk_bf16_f32 v39, v30, v31
    s_nop 0
    s_nop 0
    v_mfma_f32_16x16x32_bf16 v[84:87], a[132:135], v[36:39], v[84:87]
    s_nop 2
    v_mfma_f32_16x16x32_bf16 v[88:91], a[140:143], v[36:39], v[88:91]
    s_nop 2
    v_mfma_f32_16x16x32_bf16 v[92:95], v[32:35], v[32:35], 0
    v_cvt_pk_bf16_f32 v116, v84, v85
    v_cvt_pk_bf16_f32 v118, v86, v87
    v_cndmask_b32 v116, v116, v118, s[44:45]
    v_mfma_f32_16x16x32_bf16 v[92:95], v[36:39], v[36:39], v[92:95]
    v_cvt_pk_bf16_f32 v117, v88, v89
    v_cvt_pk_bf16_f32 v118, v90, v91
    v_cndmask_b32 v117, v117, v118, s[44:45]
    buffer_store_dwordx2 v[116:117], v8, s[40:43], s64 offen offset:0 sc1
    s_nop 3
    buffer_store_dwordx2 v[92:93], v11, s[40:43], s65 offen offset:1536 sc1
L_q1f:
    buffer_load_dwordx4 v[100:103], v9, s[40:43], s64 offen offset:0 sc1
    buffer_load_dwordx4 v[104:107], v9, s[40:43], s64 offen offset:64 sc1
    buffer_load_dwordx4 v[108:111], v10, s[40:43], s65 offen offset:1536 sc1
    s_add_u32 s59, s59, 0x10000
    s_cselect_b32 s60, -1, s60
    v_mov_b64 v[72:73], 0
    v_mov_b64 v[74:75], 0
    v_mov_b64 v[76:77], 0
    v_mov_b64 v[78:79], 0
    v_mov_b64 v[80:81], 0
    v_mov_b64 v[82:83], 0
    v_mov_b64 v[96:97], 0
    v_mov_b64 v[98:99], 0
    v_mov_b64 v[88:89], 0
    v_mov_b64 v[90:91], 0
    v_mov_b64 v[92:93], 0
    v_mov_b64 v[94:95], 0
    v_mov_b64 v[68:69], 0
    v_mov_b64 v[70:71], 0
    v_mov_b64 v[84:85], 0
    v_mov_b64 v[86:87], 0
    s_waitcnt vmcnt(1)
    v_smfmac_f32_16x16x64_bf16 v[68:71], v[100:103], a[0:7], v12
    v_max3_u32 v112, v100, v101, v102
    v_max3_u32 v112, v112, v103, v104
    v_max3_u32 v112, v112, v105, v106
    v_smfmac_f32_16x16x64_bf16 v[84:87], v[100:103], a[64:71], v12
    v_max_u32 v112, v112, v107
    v_cmp_lt_u32 vcc, s60, v112
    s_cbranch_vccnz L_q1f
    v_smfmac_f32_16x16x64_bf16 v[68:71], v[104:107], a[8:15], v12
    s_waitcnt vmcnt(0)
    v_max3_u32 v112, v108, v109, v110
    v_max_u32 v112, v112, v111
    v_smfmac_f32_16x16x64_bf16 v[84:87], v[104:107], a[72:79], v12
    v_cmp_lt_u32 vcc, s60, v112
    s_cbranch_vccnz L_sr1f
L_sb1f:
    v_add_f32 v108, v108, v110
    v_smfmac_f32_16x16x64_bf16 v[76:79], v[100:103], a[32:39], v12
    v_add_f32 v68, v68, v69
    v_add_f32 v70, v70, v71
    v_add_f32 v68, v68, v70
    v_smfmac_f32_16x16x64_bf16 v[92:95], v[100:103], a[96:103], v12
    v_add_f32 v84, v84, v85
    v_add_f32 v86, v86, v87
    v_add_f32 v84, v84, v86
    v_smfmac_f32_16x16x64_bf16 v[76:79], v[104:107], a[40:47], v12
    v_add_f32 v109, v109, v111
    v_permlane32_swap_b32 v68, v84
    v_add_f32_dpp v108, v108, v108 quad_perm:[1,0,3,2] row_mask:0xf bank_mask:0xf
    v_smfmac_f32_16x16x64_bf16 v[92:95], v[104:107], a[104:111], v12
    v_add_f32 v68, v68, v84
    v_add_f32_dpp v109, v109, v109 quad_perm:[1,0,3,2] row_mask:0xf bank_mask:0xf
    v_add_f32_dpp v108, v108, v108 quad_perm:[2,3,0,1] row_mask:0xf bank_mask:0xf
    v_smfmac_f32_16x16x64_bf16 v[72:75], v[100:103], a[16:23], v12
    v_add_f32 v76, v76, v77
    v_add_f32 v78, v78, v79
    v_add_f32 v76, v76, v78
    v_smfmac_f32_16x16x64_bf16 v[88:91], v[100:103], a[80:87], v12
    v_add_f32 v92, v92, v93
    v_add_f32 v94, v94, v95
    v_add_f32 v92, v92, v94
    v_smfmac_f32_16x16x64_bf16 v[72:75], v[104:107], a[24:31], v12
    v_add_f32_dpp v109, v109, v109 quad_perm:[2,3,0,1] row_mask:0xf bank_mask:0xf
    v_permlane32_swap_b32 v76, v92
    v_fmamk_f32 v108, v108, 0x3b000000, v15
    v_smfmac_f32_16x16x64_bf16 v[88:91], v[104:107], a[88:95], v12
    v_add_f32 v76, v76, v92
    v_mul_f32 v110, 0xbb000000, v109
    v_fma_f32 v108, -v110, v110, v108
    v_smfmac_f32_16x16x64_bf16 v[80:83], v[100:103], a[48:55], v12
    v_add_f32 v72, v72, v73
    v_add_f32 v74, v74, v75
    v_add_f32 v72, v72, v74
    v_smfmac_f32_16x16x64_bf16 v[96:99], v[100:103], a[112:119], v12
    v_add_f32 v88, v88, v89
    v_add_f32 v90, v90, v91
    v_add_f32 v88, v88, v90
    v_smfmac_f32_16x16x64_bf16 v[80:83], v[104:107], a[56:63], v12
    v_permlane16_swap_b32 v68, v76
    v_permlane32_swap_b32 v72, v88
    v_max_f32 v108, v108, v15
    v_smfmac_f32_16x16x64_bf16 v[96:99], v[104:107], a[120:127], v12
    v_rsq_f32 v111, v108
    v_add_f32 v112, v68, v76
    v_add_f32 v72, v72, v88
    v_mul_f32 v111, 0x3e0293ee, v111
    v_add_f32 v80, v80, v81
    v_add_f32 v82, v82, v83
    v_add_f32 v80, v80, v82
    v_mul_f32 v118, v41, v110
    v_add_f32 v96, v96, v97
    v_add_f32 v98, v98, v99
    v_add_f32 v96, v96, v98
    v_mul_f32 v118, v118, v111
    v_fmac_f32 v112, v40, v110
    v_permlane32_swap_b32 v80, v96
    v_add_f32 v80, v80, v96
    v_mul_f32 v112, v112, v111
    s_nop 0
    v_permlane16_swap_b32 v72, v80
    v_add_f32 v113, v72, v80
    v_fma_f32 v113, v113, v111, v118
    v_max_f32 v116, v112, v113
    v_mov_b64 v[68:69], 0
    v_mov_b64 v[70:71], 0
    v_max_f32_dpp v116, v116, v116 quad_perm:[1,0,3,2] row_mask:0xf bank_mask:0xf
    v_mov_b64 v[72:73], 0
    v_mov_b64 v[74:75], 0
    v_max_f32_dpp v116, v116, v116 quad_perm:[2,3,0,1] row_mask:0xf bank_mask:0xf
    s_nop 1
    v_max_f32_dpp v116, v116, v116 row_half_mirror row_mask:0xf bank_mask:0xf
    s_nop 1
    v_max_f32_dpp v116, v116, v116 row_mirror row_mask:0xf bank_mask:0xf
    s_nop 1
    v_max_f32_dpp v116, v116, v116 row_bcast:15 row_mask:0xa bank_mask:0xf
    s_nop 1
    v_max_f32_dpp v116, v116, v116 row_bcast:31 row_mask:0xc bank_mask:0xf
    ds_write_b32 v45, v116
    v_readlane_b32 s61, v116, 63
    s_nop 1
    v_subrev_f32 v112, s61, v112
    v_subrev_f32 v113, s61, v113
    v_exp_f32 v112, v112
    v_exp_f32 v113, v113
    v_cvt_pk_bf16_f32 v114, v112, v112
    v_cvt_pk_bf16_f32 v115, v113, v113
    v_add_f32 v117, v112, v113
    v_and_b32_dpp v76, v114, v14 row_newbcast:0 row_mask:0xf bank_mask:0xf
    v_and_b32_dpp v78, v114, v14 row_newbcast:1 row_mask:0xf bank_mask:0xf
    v_and_b32_dpp v77, v115, v14 row_newbcast:0 row_mask:0xf bank_mask:0xf
    v_and_b32_dpp v79, v115, v14 row_newbcast:1 row_mask:0xf bank_mask:0xf
    v_and_b32_dpp v80, v114, v14 row_newbcast:2 row_mask:0xf bank_mask:0xf
    v_and_b32_dpp v81, v115, v14 row_newbcast:2 row_mask:0xf bank_mask:0xf
    v_smfmac_f32_16x16x64_bf16 v[68:71], v[76:79], v[128:135], v13
    v_and_b32_dpp v82, v114, v14 row_newbcast:3 row_mask:0xf bank_mask:0xf
    v_and_b32_dpp v83, v115, v14 row_newbcast:3 row_mask:0xf bank_mask:0xf
    v_add_f32_dpp v117, v117, v117 quad_perm:[1,0,3,2] row_mask:0xf bank_mask:0xf
    v_smfmac_f32_16x16x64_bf16 v[72:75], v[76:79], v[136:143], v13
    v_and_b32_dpp v76, v114, v14 row_newbcast:4 row_mask:0xf bank_mask:0xf
    v_and_b32_dpp v77, v115, v14 row_newbcast:4 row_mask:0xf bank_mask:0xf
    v_add_f32_dpp v117, v117, v117 quad_perm:[2,3,0,1] row_mask:0xf bank_mask:0xf
    v_smfmac_f32_16x16x64_bf16 v[68:71], v[80:83], v[144:151], v13
    v_and_b32_dpp v78, v114, v14 row_newbcast:5 row_mask:0xf bank_mask:0xf
    v_and_b32_dpp v79, v115, v14 row_newbcast:5 row_mask:0xf bank_mask:0xf
    s_waitcnt lgkmcnt(0)
    v_smfmac_f32_16x16x64_bf16 v[72:75], v[80:83], v[152:159], v13
    v_and_b32_dpp v80, v114, v14 row_newbcast:6 row_mask:0xf bank_mask:0xf
    v_and_b32_dpp v81, v115, v14 row_newbcast:6 row_mask:0xf bank_mask:0xf
    s_barrier
    v_smfmac_f32_16x16x64_bf16 v[68:71], v[76:79], v[160:167], v13
    v_and_b32_dpp v82, v114, v14 row_newbcast:7 row_mask:0xf bank_mask:0xf
    v_and_b32_dpp v83, v115, v14 row_newbcast:7 row_mask:0xf bank_mask:0xf
    ds_read_b128 v[100:103], v46
    v_smfmac_f32_16x16x64_bf16 v[72:75], v[76:79], v[168:175], v13
    v_and_b32_dpp v76, v114, v14 row_newbcast:8 row_mask:0xf bank_mask:0xf
    v_and_b32_dpp v77, v115, v14 row_newbcast:8 row_mask:0xf bank_mask:0xf
    v_add_f32_dpp v117, v117, v117 row_half_mirror row_mask:0xf bank_mask:0xf
    v_smfmac_f32_16x16x64_bf16 v[68:71], v[80:83], v[176:183], v13
    v_and_b32_dpp v78, v114, v14 row_newbcast:9 row_mask:0xf bank_mask:0xf
    v_and_b32_dpp v79, v115, v14 row_newbcast:9 row_mask:0xf bank_mask:0xf
    v_add_f32_dpp v117, v117, v117 row_mirror row_mask:0xf bank_mask:0xf
    v_smfmac_f32_16x16x64_bf16 v[72:75], v[80:83], v[184:191], v13
    v_and_b32_dpp v80, v114, v14 row_newbcast:10 row_mask:0xf bank_mask:0xf
    v_and_b32_dpp v81, v115, v14 row_newbcast:10 row_mask:0xf bank_mask:0xf
    v_add_f32_dpp v117, v117, v117 row_bcast:15 row_mask:0xa bank_mask:0xf
    v_smfmac_f32_16x16x64_bf16 v[68:71], v[76:79], v[192:199], v13
    v_and_b32_dpp v82, v114, v14 row_newbcast:11 row_mask:0xf bank_mask:0xf
    v_and_b32_dpp v83, v115, v14 row_newbcast:11 row_mask:0xf bank_mask:0xf
    v_add_f32_dpp v117, v117, v117 row_bcast:31 row_mask:0xc bank_mask:0xf
    v_smfmac_f32_16x16x64_bf16 v[72:75], v[76:79], v[200:207], v13
    v_and_b32_dpp v76, v114, v14 row_newbcast:12 row_mask:0xf bank_mask:0xf
    v_and_b32_dpp v77, v115, v14 row_newbcast:12 row_mask:0xf bank_mask:0xf
    buffer_store_dwordx2 v[116:117], v49, s[40:43], s65 offen offset:1792 sc1
    v_smfmac_f32_16x16x64_bf16 v[68:71], v[80:83], v[208:215], v13
    v_and_b32_dpp v78, v114, v14 row_newbcast:13 row_mask:0xf bank_mask:0xf
    v_and_b32_dpp v79, v115, v14 row_newbcast:13 row_mask:0xf bank_mask:0xf
    s_waitcnt lgkmcnt(0)
    v_smfmac_f32_16x16x64_bf16 v[72:75], v[80:83], v[216:223], v13
    v_and_b32_dpp v80, v114, v14 row_newbcast:14 row_mask:0xf bank_mask:0xf
    v_and_b32_dpp v81, v115, v14 row_newbcast:14 row_mask:0xf bank_mask:0xf
    v_max3_f32 v118, v100, v101, v102
    v_smfmac_f32_16x16x64_bf16 v[68:71], v[76:79], v[224:231], v13
    v_and_b32_dpp v82, v114, v14 row_newbcast:15 row_mask:0xf bank_mask:0xf
    v_and_b32_dpp v83, v115, v14 row_newbcast:15 row_mask:0xf bank_mask:0xf
    v_max_f32 v118, v118, v103
    v_smfmac_f32_16x16x64_bf16 v[72:75], v[76:79], v[232:239], v13
    v_sub_f32 v100, v100, v118
    v_sub_f32 v101, v101, v118
    v_sub_f32 v102, v102, v118
    v_smfmac_f32_16x16x64_bf16 v[68:71], v[80:83], v[240:247], v13
    v_sub_f32 v103, v103, v118
    s_cmp_ge_u32 s54, 2
    s_nop 0
    v_smfmac_f32_16x16x64_bf16 v[72:75], v[80:83], v[248:255], v13
    s_mov_b64 exec, 0xffff
    s_nop 2
    ds_write_b128 v44, v[68:71]
    s_nop 2
    ds_write_b128 v44, v[72:75] offset:16
    s_mov_b64 exec, -1
    v_exp_f32 v100, v100
    v_exp_f32 v101, v101
    v_exp_f32 v102, v102
    v_exp_f32 v103, v103
    s_waitcnt lgkmcnt(0)
    s_barrier
    s_cbranch_scc1 L_x1f
    ds_read2st64_b64 v[68:71], v47 offset0:0 offset1:1
    ds_read2st64_b64 v[72:75], v47 offset0:2 offset1:3
    buffer_load_dwordx4 v[108:111], v50, s[40:43], s65 offen offset:1792 sc1
    v_mov_b64 v[76:77], 0
    v_mov_b64 v[78:79], 0
    v_mov_b64 v[80:81], 0
    v_mov_b64 v[82:83], 0
    s_waitcnt lgkmcnt(1)
    v_pk_mul_f32 v[68:69], v[68:69], v[100:101] op_sel_hi:[1,0]
    v_pk_fma_f32 v[68:69], v[70:71], v[100:101], v[68:69] op_sel:[0,1,0]
    s_waitcnt lgkmcnt(0)
    v_pk_fma_f32 v[68:69], v[72:73], v[102:103], v[68:69] op_sel_hi:[1,0,1]
    v_pk_fma_f32 v[68:69], v[74:75], v[102:103], v[68:69] op_sel:[0,1,0]
    v_cvt_pk_bf16_f32 v68, v68, v69
    buffer_store_dword v68, v48, s[40:43], s64 offen offset:2048 sc1
    buffer_load_dwordx4 v[100:103], v9, s[40:43], s64 offen offset:2048 sc1
    buffer_load_dwordx4 v[104:107], v9, s[40:43], s64 offen offset:2112 sc1
    s_waitcnt vmcnt(3)
L_m1f:
    v_max_f32 v113, v108, v110
    v_max3_u32 v112, v108, v109, v110
    v_max_u32 v112, v112, v111
    v_max_f32_dpp v113, v113, v113 quad_perm:[1,0,3,2] row_mask:0xf bank_mask:0xf
    v_cmp_lt_u32 vcc, s60, v112
    s_cbranch_vccnz L_mr1f
    v_max_f32_dpp v114, v113, v113 quad_perm:[2,3,0,1] row_mask:0xf bank_mask:0xf
    s_nop 1
    v_max_f32_dpp v114, v114, v114 row_half_mirror row_mask:0xf bank_mask:0xf
    s_nop 1
    v_max_f32_dpp v114, v114, v114 row_mirror row_mask:0xf bank_mask:0xf
    v_sub_f32 v108, v108, v114
    v_sub_f32 v110, v110, v114
    v_exp_f32 v108, v108
    v_exp_f32 v110, v110
    v_mul_f32 v115, v108, v109
    v_fmac_f32 v115, v110, v111
    v_sub_f32 v113, v113, v114
    v_exp_f32 v113, v113
    v_add_f32_dpp v115, v115, v115 quad_perm:[1,0,3,2] row_mask:0xf bank_mask:0xf
    s_nop 1
    v_add_f32_dpp v115, v115, v115 quad_perm:[2,3,0,1] row_mask:0xf bank_mask:0xf
    s_nop 1
    v_add_f32_dpp v115, v115, v115 row_half_mirror row_mask:0xf bank_mask:0xf
    s_nop 1
    v_add_f32_dpp v115, v115, v115 row_mirror row_mask:0xf bank_mask:0xf
    v_rcp_f32 v115, v115
    s_nop 1
    v_mul_f32_dpp v114, v113, v115 row_newbcast:0 row_mask:0xf bank_mask:0xf
    v_mul_f32_dpp v113, v113, v115 row_newbcast:2 row_mask:0xf bank_mask:0xf
    v_cvt_pk_bf16_f32 v114, v114, v113
    v_cndmask_b32 v120, v114, 0, s[50:51]
    v_cndmask_b32 v121, v114, 0, s[50:51]
    v_cndmask_b32 v122, 0, v114, s[50:51]
    v_cndmask_b32 v123, 0, v114, s[50:51]
    s_branch L_o1f
L_mr1f:
    buffer_load_dwordx4 v[108:111], v50, s[40:43], s65 offen offset:1792 sc1
    buffer_load_dwordx4 v[100:103], v9, s[40:43], s64 offen offset:2048 sc1
    buffer_load_dwordx4 v[104:107], v9, s[40:43], s64 offen offset:2112 sc1
    s_add_u32 s59, s59, 0x10000
    s_cselect_b32 s60, -1, s60
    s_waitcnt vmcnt(2)
    s_branch L_m1f
L_s1f:
    s_nop 1
    v_mfma_f32_16x16x32_bf16 v[92:95], v[32:35], v[32:35], 0
    v_cvt_pk_bf16_f32 v36, v24, v25
    v_cvt_pk_bf16_f32 v37, v26, v27
    v_cvt_pk_bf16_f32 v38, v28, v29
    v_cvt_pk_bf16_f32 v39, v30, v31
    s_nop 1
    v_mfma_f32_16x16x32_bf16 v[92:95], v[36:39], v[36:39], v[92:95]
    s_nop 7
    buffer_store_dwordx2 v[92:93], v11, s[40:43], s65 offen offset:1664 sc1
    s_branch L_fin
L_or1f:
    buffer_load_dwordx4 v[100:103], v9, s[40:43], s64 offen offset:2048 sc1
    buffer_load_dwordx4 v[104:107], v9, s[40:43], s64 offen offset:2112 sc1
    s_add_u32 s59, s59, 0x10000
    s_cselect_b32 s60, -1, s60
    s_nop 2
    v_mov_b64 v[76:77], 0
    v_mov_b64 v[78:79], 0
    v_mov_b64 v[80:81], 0
    v_mov_b64 v[82:83], 0
L_o1f:
    s_waitcnt vmcnt(1)
    v_smfmac_f32_16x16x64_bf16 v[76:79], v[100:103], a[144:151], v12
    v_max3_u32 v112, v100, v101, v102
    s_waitcnt vmcnt(0)
    v_max3_u32 v112, v112, v103, v104
    v_smfmac_f32_16x16x64_bf16 v[80:83], v[100:103], a[160:167], v12
    v_max3_u32 v112, v112, v105, v106
    v_max_u32 v112, v112, v107
    v_cmp_lt_u32 vcc, s60, v112
    v_smfmac_f32_16x16x64_bf16 v[76:79], v[104:107], a[152:159], v12
    s_cbranch_vccnz L_or1f
    s_nop 1
    v_smfmac_f32_16x16x64_bf16 v[80:83], v[104:107], a[168:175], v12
    s_nop 3
    v_cvt_pk_bf16_f32 v84, v76, v77
    v_cvt_pk_bf16_f32 v85, v78, v79
    s_nop 1
    v_cvt_pk_bf16_f32 v86, v80, v81
    v_cvt_pk_bf16_f32 v87, v82, v83
    s_nop 1
    v_mfma_f32_16x16x32_bf16 v[88:91], v[120:123], v[84:87], 0
    s_nop 7
    v_cvt_pk_bf16_f32 v88, v88, v89
    buffer_store_dword v88, v51, s[40:43], s68 offen offset:0 sc1
    buffer_store_dword v88, v51, s[40:43], s49 offen offset:0 sc1
    s_mov_b64 vcc, -1
    s_waitcnt vmcnt(0)
L_g1f:
    s_mov_b64 exec, vcc
    buffer_load_dwordx4 v[100:103], v52, s[40:43], s68 offen offset:0 sc1
    buffer_load_dwordx4 v[104:107], v52, s[40:43], s68 offen offset:1024 sc1
    s_add_u32 s59, s59, 0x10000
    s_cselect_b32 s60, -1, s60
    s_waitcnt vmcnt(1)
    ds_write2_b64 v54, v[100:101], v[102:103] offset0:0 offset1:128
    v_max3_u32 v112, v100, v101, v102
    s_waitcnt vmcnt(0)
    ds_write2_b64 v54, v[104:105], v[106:107] offset0:32 offset1:160
    v_max3_u32 v112, v112, v103, v104
    v_max3_u32 v112, v112, v105, v106
    v_max_u32 v112, v112, v107
    v_cmp_lt_u32 vcc, s60, v112
    s_cbranch_vccnz L_g1f
    s_mov_b64 exec, -1
    s_waitcnt lgkmcnt(0)
L_x1f:
    s_cmp_eq_u32 s54, 3
    s_barrier
    ds_read_b64_tr_b16 v[68:69], v53 offset:0
    ds_read_b64_tr_b16 v[70:71], v53 offset:512
    ds_read_b64_tr_b16 v[72:73], v53 offset:1024
    ds_read_b64_tr_b16 v[74:75], v53 offset:1536
    ds_read_b64_tr_b16 v[76:77], v53 offset:2176
    ds_read_b64_tr_b16 v[78:79], v53 offset:2688
    ds_read_b64_tr_b16 v[80:81], v53 offset:3200
    ds_read_b64_tr_b16 v[82:83], v53 offset:3712
    s_waitcnt lgkmcnt(6)
    v_mfma_f32_16x16x32_bf16 v[16:19], v[68:71], a[208:211], v[16:19]
    s_waitcnt lgkmcnt(4)
    s_nop 1
    v_mfma_f32_16x16x32_bf16 v[20:23], v[72:75], a[208:211], v[20:23]
    s_waitcnt lgkmcnt(2)
    s_nop 1
    v_mfma_f32_16x16x32_bf16 v[24:27], v[76:79], a[208:211], v[24:27]
    v_cvt_pk_bf16_f32 v32, v16, v17
    v_cvt_pk_bf16_f32 v33, v18, v19
    s_waitcnt lgkmcnt(0)
    v_mfma_f32_16x16x32_bf16 v[28:31], v[80:83], a[208:211], v[28:31]
    v_cvt_pk_bf16_f32 v34, v20, v21
    v_cvt_pk_bf16_f32 v35, v22, v23
    s_cbranch_scc1 L_s1f
    s_nop 0
    v_mfma_f32_16x16x32_bf16 v[84:87], v[32:35], a[176:179], 0
    v_cvt_pk_bf16_f32 v36, v24, v25
    v_cvt_pk_bf16_f32 v37, v26, v27
    s_nop 0
    v_mfma_f32_16x16x32_bf16 v[88:91], v[32:35], a[184:187], 0
    v_cvt_pk_bf16_f32 v38, v28, v29
    v_cvt_pk_bf16_f32 v39, v30, v31
    s_nop 0
    s_nop 0
    v_mfma_f32_16x16x32_bf16 v[84:87], v[36:39], a[180:183], v[84:87]
    s_nop 2
    v_mfma_f32_16x16x32_bf16 v[88:91], v[36:39], a[188:191], v[88:91]
    s_cmp_eq_u32 s54, 2
    s_nop 6
    v_cvt_pk_bf16_f32 v112, v84, v88
    buffer_store_dword v112, v55, s[40:43], s65 offen offset:0 sc1
    s_cbranch_scc1 L_fin
    v_mov_b64 v[68:69], 0
    v_mov_b64 v[70:71], 0
    v_mov_b64 v[72:73], 0
    v_mov_b64 v[74:75], 0
L_c1f:
    buffer_load_dwordx4 v[108:111], v10, s[40:43], s65 offen offset:1664 sc1
    buffer_load_dwordx4 v[100:103], v56, s[40:43], s65 offen offset:0 sc1
    buffer_load_dwordx4 v[104:107], v56, s[40:43], s65 offen offset:16 sc1
    s_add_u32 s59, s59, 0x10000
    s_cselect_b32 s60, -1, s60
    s_waitcnt vmcnt(2)
    v_pk_add_f32 v[114:115], v[108:109], v[110:111]
    v_max3_u32 v112, v108, v109, v110
    s_waitcnt vmcnt(1)
    v_mfma_f32_16x16x32_bf16 v[76:79], a[212:215], v[100:103], 0
    v_add_f32_dpp v115, v115, v115 quad_perm:[1,0,3,2] row_mask:0xf bank_mask:0xf
    v_add_f32_dpp v114, v114, v114 quad_perm:[1,0,3,2] row_mask:0xf bank_mask:0xf
    v_max3_u32 v112, v112, v111, v100
    s_waitcnt vmcnt(0)
    v_mfma_f32_16x16x32_bf16 v[76:79], a[212:215], v[104:107], v[76:79]
    v_max3_u32 v112, v112, v101, v102
    v_max3_u32 v112, v112, v103, v104
    v_max3_u32 v112, v112, v105, v106
    v_max_u32 v112, v112, v107
    v_cmp_lt_u32 vcc, s60, v112
    v_add_f32_dpp v109, v115, v115 quad_perm:[2,3,0,1] row_mask:0xf bank_mask:0xf
    s_cbranch_vccnz L_c1f
    v_add_f32_dpp v108, v114, v114 quad_perm:[2,3,0,1] row_mask:0xf bank_mask:0xf
    v_mul_f32 v110, 0xbb000000, v109
    v_fmamk_f32 v108, v108, 0x3b000000, v15
    v_fma_f32 v108, -v110, v110, v108
    v_max_f32 v108, v108, v15
    v_rsq_f32 v112, v108
    v_pk_fma_f32 v[76:77], v[42:43], v[110:111], v[76:77] op_sel_hi:[1,0,1]
    v_mul_f32 v112, 0xbfb8aa3b, v112
    v_mul_f32 v112, v76, v112
    v_exp_f32 v112, v112
    v_mul_f32 v76, v76, v77
    v_fmac_f32 v108, v112, v108
    v_rcp_f32 v108, v108
    s_nop 0
    v_mul_f32 v76, v76, v108
    v_cvt_pk_bf16_f32 v76, v76, v76
    v_and_b32 v100, v76, v57
    v_and_b32 v101, v76, v58
    v_and_b32 v102, v76, v59
    v_and_b32 v103, v76, v60
    s_nop 1
    v_smfmac_f32_16x16x64_bf16 v[68:71], v[100:103], a[192:199], v13
    s_nop 2
    v_smfmac_f32_16x16x64_bf16 v[72:75], v[100:103], a[200:207], v13
    s_nop 3
    v_cvt_pk_bf16_f32 v84, v68, v69
    v_cvt_pk_bf16_f32 v85, v70, v71
    s_nop 1
    v_cvt_pk_bf16_f32 v86, v72, v73
    v_cvt_pk_bf16_f32 v87, v74, v75
    s_nop 1
    v_mfma_f32_16x16x32_bf16 v[88:91], a[216:219], v[84:87], 0
    s_cmp_lg_u32 s52, 0
    s_mov_b64 exec, 0xffff
    s_nop 5
    v_cvt_pk_bf16_f32 v88, v88, v89
    buffer_store_dword v88, v51, s[40:43], s69 offen offset:0 sc1
    s_mov_b64 exec, -1
    s_cbranch_scc1 L_fin
    s_lshl4_add_u32 s56, s53, s54
    s_lshl_b32 s56, s56, 3
    v_lshl_add_u32 v64, v3, 5, s56
    v_lshl_add_u32 v64, v2, 10, v64
    s_cmp_eq_u32 s54, 0
    s_cbranch_scc1 L_z1f
    v_add_u32 v53, 2176, v53
    v_mov_b64 v[16:17], v[24:25]
    v_mov_b64 v[18:19], v[26:27]
    v_mov_b64 v[20:21], v[28:29]
    v_mov_b64 v[22:23], v[30:31]
L_z1f:
    s_mov_b64 vcc, -1
    s_waitcnt vmcnt(0)
L_h1f:
    s_mov_b64 exec, vcc
    buffer_load_dwordx4 v[100:103], v52, s[40:43], s69 offen offset:0 sc1
    buffer_load_dwordx4 v[104:107], v52, s[40:43], s69 offen offset:1024 sc1
    s_add_u32 s59, s59, 0x10000
    s_cselect_b32 s60, -1, s60
    s_waitcnt vmcnt(1)
    ds_write2_b64 v54, v[100:101], v[102:103] offset0:0 offset1:128
    v_max3_u32 v112, v100, v101, v102
    s_waitcnt vmcnt(0)
    ds_write2_b64 v54, v[104:105], v[106:107] offset0:32 offset1:160
    v_max3_u32 v112, v112, v103, v104
    v_max3_u32 v112, v112, v105, v106
    v_max_u32 v112, v112, v107
    v_cmp_lt_u32 vcc, s60, v112
    s_cbranch_vccnz L_h1f
    s_mov_b64 exec, -1
    s_waitcnt lgkmcnt(0)
    s_barrier
    ds_read_b64_tr_b16 v[68:69], v53 offset:0
    ds_read_b64_tr_b16 v[70:71], v53 offset:512
    ds_read_b64_tr_b16 v[72:73], v53 offset:1024
    ds_read_b64_tr_b16 v[74:75], v53 offset:1536
    s_waitcnt lgkmcnt(2)
    v_mfma_f32_16x16x32_bf16 v[16:19], v[68:71], a[208:211], v[16:19]
    s_waitcnt lgkmcnt(0)
    s_nop 1
    v_mfma_f32_16x16x32_bf16 v[20:23], v[72:75], a[208:211], v[20:23]
    s_nop 3
    v_cvt_pk_bf16_f32 v32, v16, v18
    v_cvt_pk_bf16_f32 v34, v17, v19
    s_nop 1
    v_cvt_pk_bf16_f32 v33, v20, v22
    buffer_store_dwordx2 v[32:33], v64, s[32:35], 0 offen
    v_cvt_pk_bf16_f32 v35, v21, v23
    buffer_store_dwordx2 v[34:35], v64, s[32:35], 0 offen offset:16
    s_branch L_fin
L_w0f:
    s_waitcnt vmcnt(0)
    s_barrier
    v_lshrrev_b32 v124, 2, v1
    v_mul_u32_u24 v124, 96, v124
    v_and_b32 v125, 3, v0
    v_lshlrev_b32 v125, 3, v125
    s_lshl_b32 s56, s54, 5
    s_add_u32 s56, s56, 66560
    v_add3_u32 v64, v124, v125, s56
    s_cmp_eq_u32 s54, 3
    s_cselect_b32 s55, 36352, 0
    s_cselect_b32 s57, 3072, 0
    s_barrier
    s_add_u32 m0, s55, 66560
    s_mov_b32 s58, 0
    buffer_load_dwordx4 v61, s[24:27], s58 offen nt lds
    s_add_u32 m0, s55, 67584
    s_mov_b32 s58, 0
    buffer_load_dwordx4 v62, s[24:27], s58 offen nt lds
    s_add_u32 m0, s55, 68608
    s_mov_b32 s58, 0
    buffer_load_dwordx4 v63, s[24:27], s58 offen nt lds
    s_add_u32 m0, s55, 69632
    s_mov_b32 s58, 11008
    buffer_load_dwordx4 v61, s[24:27], s58 offen nt lds
    s_add_u32 m0, s55, 70656
    s_mov_b32 s58, 11008
    buffer_load_dwordx4 v62, s[24:27], s58 offen nt lds
    s_add_u32 m0, s55, 71680
    s_mov_b32 s58, 11008
    buffer_load_dwordx4 v63, s[24:27], s58 offen nt lds
    s_add_u32 m0, s57, 96768
    s_mov_b32 s58, 0
    buffer_load_dwordx4 v7, s[28:31], s58 offen nt lds
    s_add_u32 m0, s57, 97792
    s_mov_b32 s58, 8192
    buffer_load_dwordx4 v7, s[28:31], s58 offen nt lds
    s_add_u32 m0, s57, 98816
    s_mov_b32 s58, 16384
    buffer_load_dwordx4 v7, s[28:31], s58 offen nt lds
    s_waitcnt vmcnt(0)
    s_branch L_x0f
L_sr1f:
    buffer_load_dwordx4 v[108:111], v10, s[40:43], s65 offen offset:1536 sc1
    s_add_u32 s59, s59, 0x10000
    s_cselect_b32 s60, -1, s60
    s_waitcnt vmcnt(0)
    v_max3_u32 v112, v108, v109, v110
    v_max_u32 v112, v112, v111
    v_cmp_lt_u32 vcc, s60, v112
    s_cbranch_vccnz L_sr1f
    s_branch L_sb1f
.section .rodata,"a"
.p2align 6
.amdhsa_kernel interleave_layers__mha_block_cached__swiglu_ffn__decode_kernel
  .amdhsa_next_free_vgpr 512
  .amdhsa_next_free_sgpr 102
  .amdhsa_accum_offset 256
  .amdhsa_group_segment_fixed_size 0
  .amdhsa_kernarg_size 96
  .amdhsa_user_sgpr_count 2
  .amdhsa_user_sgpr_kernarg_segment_ptr 1
  .amdhsa_system_sgpr_workgroup_id_x 1
  .amdhsa_float_denorm_mode_32 3
.end_amdhsa_kernel
```
